```python
import torch

def _softmax(x, axis=-1):
    return torch.softmax(x, dim=axis)
def _gelu(x):
    return torch.nn.functional.gelu(x, approximate="tanh")
def _silu(x):
    return torch.nn.functional.silu(x)
def _sigmoid(x):
    return torch.sigmoid(x)
def _layernorm(x, axis=-1, eps=1e-5):
    m = x.mean(dim=axis, keepdim=True)
    v = x.var(dim=axis, keepdim=True, unbiased=False)
    return (x - m) / torch.sqrt(v + eps)
def _scatter_add(tgt, idx, src, axis=0):
    return tgt.clone().index_add_(axis, idx, src)
def _segment_sum(src, seg, n):
    out = torch.zeros((n,) + src.shape[1:], dtype=src.dtype)
    return out.index_add_(0, seg, src)
def _pad(x, pw):
    flat = tuple(v for pair in reversed(pw) for v in pair)
    return torch.nn.functional.pad(x, flat)

kernel_name = 'gated_mix__ssm_conv_h3__sliding_block__prompt'

def setup_inputs():

    _w = (lambda a: (lambda t: t.to(torch.bfloat16) if t.is_floating_point() else t)(torch.as_tensor(a)))
    def _A_setup():
        B, S, D = 1, 2048, 512
        ks = 4
        return {
            "q": _w((lambda *s: torch.randn(*s, dtype=torch.bfloat16) * 0.05)(B, S, D)),
            "k": _w((lambda *s: torch.randn(*s, dtype=torch.bfloat16) * 0.8)(B, S, D)),
            "v": _w((lambda *s: torch.randn(*s, dtype=torch.bfloat16) * 0.8)(B, S, D)),
            "shift_k": _w((lambda *s: torch.randn(*s, dtype=torch.bfloat16) * 0.8)(D, ks) * 0.5),
            "ssm_k": _w((lambda *s: torch.randn(*s, dtype=torch.bfloat16) * 1.6)(D, S) * (1.0 / S ** 0.5)),
            "ssm_D": _w((lambda *s: torch.randn(*s, dtype=torch.bfloat16) * 0.8)(D)),
        }
    _A_in = _A_setup()

    def _B_setup():
        B, S, D = 1, 2048, 512
        return {
            "x": _w((lambda *s: torch.randn(*s, dtype=torch.bfloat16) * 0.05)(B, S, D)),
            "wqkv": _w((lambda *s: torch.randn(*s, dtype=torch.bfloat16) * 0.8)(D, 3 * D)),
            "wo": _w((lambda *s: torch.randn(*s, dtype=torch.bfloat16) * 0.05)(D, D)),
        }
    _B_in = _B_setup()

    return {
        "A_q": _A_in["q"],
        "A_k": _A_in["k"],
        "A_v": _A_in["v"],
        "A_shift_k": _A_in["shift_k"],
        "A_ssm_k": _A_in["ssm_k"],
        "A_ssm_D": _A_in["ssm_D"],
        "B_x": _B_in["x"],
        "B_wqkv": _B_in["wqkv"],
        "B_wo": _B_in["wo"],
        "gate_w": _w((lambda *s: torch.randn(*s, dtype=torch.bfloat16) * 0.05)(512) * 16.0),
    }

def reference(A_q, A_k, A_v, A_shift_k, A_ssm_k, A_ssm_D, B_x, B_wqkv, B_wo, gate_w):
    def _A_ref(q, k, v, shift_k, ssm_k, ssm_D):
        B, S, D = q.shape
        ks = shift_k.shape[-1]
        k_pad = _pad(k, ((0, 0), (ks - 1, 0), (0, 0)))
        k_shift = torch.zeros_like(k)
        for t in range(ks):
            k_shift = k_shift + k_pad[:, t:t + S, :] * shift_k[:, ks - 1 - t][None, None, :]
        kv = k_shift * v
        L = 2 * S
        kv_pad = _pad(kv, ((0, 0), (0, S), (0, 0)))
        kf_pad = _pad(ssm_k, ((0, 0), (0, S)))
        kv_f = (lambda x, axes=(-2,-1): torch.fft.rfft2(x.float(), dim=axes))(kv_pad[:, None, :, :], axes=(1, 2))
        kf_f = (lambda x, axes=(-2,-1): torch.fft.rfft2(x.float(), dim=axes))(kf_pad[:, None, :], axes=(1, 2))
        kf_f = (lambda x, *d: x.permute(*d))(kf_f, 1, 2, 0)
        y_f = kv_f * kf_f[None, :, :, :]
        y = (lambda x, s, axes=(-2,-1): torch.fft.irfft2(x, s=s, dim=axes).to(torch.bfloat16))(y_f, (1, L), axes=(1, 2))[:, 0, :S, :]
        y = y + kv * ssm_D[None, None, :]
        return q * y

    def _B_ref(x, wqkv, wo):
        B, S, D = x.shape
        H = 32; Dh = D // H; W = 256
        qkv = (lambda x, *d: x.permute(*d))((x @ wqkv).reshape(B, S, 3, H, Dh), 2, 0, 3, 1, 4)
        q, k, v = qkv[0], qkv[1], qkv[2]
        scores = torch.einsum("bhqd,bhkd->bhqk", q, k) * (Dh ** -0.5)
        idx = torch.arange(S)
        mask = (idx[:, None] - idx[None, :] >= 0) & (idx[:, None] - idx[None, :] < W)
        scores = torch.where(mask[None, None], scores, -1e9)
        p = _softmax(scores, axis=-1)
        o = torch.einsum("bhqk,bhkd->bhqd", p, v)
        return (lambda x, *d: x.permute(*d))(o, 0, 2, 1, 3).reshape(B, S, D) @ wo

    x = A_q
    g = _sigmoid((x * gate_w).sum(-1, keepdims=True))
    a = _A_ref(x, A_k, A_v, A_shift_k, A_ssm_k, A_ssm_D)
    b = _B_ref(x, B_wqkv, B_wo)
    return g * a + (1 - g) * b
```

```asm
; @launch kernel=k1_kernel grid=(320,1,1) block=(256,1,1) lds=77824
; @launch kernel=k2_kernel grid=(1536,1,1) block=(256,1,1) lds=26800
; @launch kernel=gated_mix__ssm_conv_h3__sliding_block__prompt_kernel grid=(256,1,1) block=(256,1,1) lds=43008
.amdgcn_target "amdgcn-amd-amdhsa--gfx950"
.text
.globl k1_kernel
.p2align 8
.type k1_kernel,@function
k1_kernel:

    s_cmp_ge_u32 s2, 320
    s_cbranch_scc1 Lexit_k1_kernel
    s_cmp_ge_u32 s2, 192
    s_cbranch_scc1 Lnext_1
    s_load_dwordx2 s[4:5], s[0:1], 0
    s_load_dwordx2 s[6:7], s[0:1], 56
    s_load_dwordx2 s[8:9], s[0:1], 96

    s_and_b32 s24, s2, 15
    s_lshr_b32 s25, s2, 4
    v_and_b32 v1, 63, v0
    v_lshrrev_b32 v14, 6, v0
    s_nop 0
    v_readfirstlane_b32 s26, v14
    s_waitcnt lgkmcnt(0)
    s_and_b32 s27, s26, 1
    s_lshr_b32 s28, s26, 1

    s_mov_b32 s12, s4
    s_mov_b32 s13, s5
    s_mov_b32 s14, 2097152
    s_mov_b32 s15, 0x00020000
    s_mov_b32 s16, s6
    s_mov_b32 s17, s7
    s_mov_b32 s18, 1572864
    s_mov_b32 s19, 0x00020000

    s_mov_b32 s20, s8
    s_mov_b32 s21, s9
    s_mov_b32 s22, 16777216
    s_mov_b32 s23, 0x00020000

    v_lshrrev_b32 v14, 3, v0
    v_and_b32 v15, 7, v0
    s_lshl_b32 s29, s24, 7
    v_add_u32 v16, s29, v14
    v_lshlrev_b32 v16, 10, v16
    v_lshl_add_u32 v2, v15, 4, v16

    v_add_u32 v3, 32768, v2
    v_add_u32 v4, 65536, v2
    v_add_u32 v5, 98304, v2
    v_mul_u32_u24 v16, 144, v14
    v_lshl_add_u32 v10, v15, 4, v16

    v_lshrrev_b32 v14, 4, v0
    v_and_b32 v15, 15, v0
    s_mov_b32 s30, 3072
    v_mul_lo_u32 v16, s30, v14
    v_lshl_add_u32 v16, v15, 4, v16
    s_lshl_b32 s29, s25, 8
    v_add_u32 v6, s29, v16

    v_add_u32 v7, 49152, v6
    v_add_u32 v8, 98304, v6
    v_add_u32 v9, 147456, v6
    v_mul_u32_u24 v16, 320, v14
    v_lshl_add_u32 v11, v15, 4, v16
    v_add_u32 v11, 18432, v11

    v_and_b32 v14, 31, v1
    s_mul_i32 s29, s28, 64
    v_add_u32 v14, s29, v14
    v_mul_u32_u24 v14, 144, v14
    v_lshrrev_b32 v15, 5, v1
    v_lshl_add_u32 v12, v15, 4, v14

    v_lshrrev_b32 v14, 5, v1
    v_lshlrev_b32 v14, 3, v14
    v_bfe_u32 v15, v1, 2, 2
    v_add_u32 v14, v14, v15
    v_mul_u32_u24 v14, 320, v14
    v_bfe_u32 v15, v1, 4, 1
    v_lshlrev_b32 v15, 5, v15
    v_and_b32 v16, 3, v1
    v_lshlrev_b32 v16, 3, v16
    v_add3_u32 v14, v14, v15, v16
    s_mul_i32 s29, s27, 128
    s_add_u32 s29, s29, 18432
    v_add_u32 v13, s29, v14

    s_cmp_ge_u32 s25, 8
    s_cbranch_scc1 Lv_2
    v_mov_b32 v148, 0
    v_mov_b32 v149, 0
    v_mov_b32 v150, 0
    v_mov_b32 v151, 0
    v_mov_b32 v152, 0
    v_mov_b32 v153, 0
    v_mov_b32 v154, 0
    v_mov_b32 v155, 0
    v_mov_b32 v156, 0
    v_mov_b32 v157, 0
    v_mov_b32 v158, 0
    v_mov_b32 v159, 0
    v_mov_b32 v160, 0
    v_mov_b32 v161, 0
    v_mov_b32 v162, 0
    v_mov_b32 v163, 0
    v_mov_b32 v164, 0
    v_mov_b32 v165, 0
    v_mov_b32 v166, 0
    v_mov_b32 v167, 0
    v_mov_b32 v168, 0
    v_mov_b32 v169, 0
    v_mov_b32 v170, 0
    v_mov_b32 v171, 0
    v_mov_b32 v172, 0
    v_mov_b32 v173, 0
    v_mov_b32 v174, 0
    v_mov_b32 v175, 0
    v_mov_b32 v176, 0
    v_mov_b32 v177, 0
    v_mov_b32 v178, 0
    v_mov_b32 v179, 0
    v_mov_b32 v180, 0
    v_mov_b32 v181, 0
    v_mov_b32 v182, 0
    v_mov_b32 v183, 0
    v_mov_b32 v184, 0
    v_mov_b32 v185, 0
    v_mov_b32 v186, 0
    v_mov_b32 v187, 0
    v_mov_b32 v188, 0
    v_mov_b32 v189, 0
    v_mov_b32 v190, 0
    v_mov_b32 v191, 0
    v_mov_b32 v192, 0
    v_mov_b32 v193, 0
    v_mov_b32 v194, 0
    v_mov_b32 v195, 0
    v_mov_b32 v196, 0
    v_mov_b32 v197, 0
    v_mov_b32 v198, 0
    v_mov_b32 v199, 0
    v_mov_b32 v200, 0
    v_mov_b32 v201, 0
    v_mov_b32 v202, 0
    v_mov_b32 v203, 0
    v_mov_b32 v204, 0
    v_mov_b32 v205, 0
    v_mov_b32 v206, 0
    v_mov_b32 v207, 0
    v_mov_b32 v208, 0
    v_mov_b32 v209, 0
    v_mov_b32 v210, 0
    v_mov_b32 v211, 0
    s_mov_b32 s31, 0
    s_mov_b32 s32, 0
    buffer_load_dwordx4 v[20:23], v2, s[12:15], s31 offen
    buffer_load_dwordx4 v[24:27], v3, s[12:15], s31 offen
    buffer_load_dwordx4 v[28:31], v4, s[12:15], s31 offen
    buffer_load_dwordx4 v[32:35], v5, s[12:15], s31 offen
    buffer_load_dwordx4 v[36:39], v6, s[16:19], s32 offen
    buffer_load_dwordx4 v[40:43], v7, s[16:19], s32 offen
    buffer_load_dwordx4 v[44:47], v8, s[16:19], s32 offen
    buffer_load_dwordx4 v[48:51], v9, s[16:19], s32 offen
    s_mov_b32 s31, 128
    s_mov_b32 s32, 196608
    buffer_load_dwordx4 v[52:55], v2, s[12:15], s31 offen
    buffer_load_dwordx4 v[56:59], v3, s[12:15], s31 offen
    buffer_load_dwordx4 v[60:63], v4, s[12:15], s31 offen
    buffer_load_dwordx4 v[64:67], v5, s[12:15], s31 offen
    buffer_load_dwordx4 v[68:71], v6, s[16:19], s32 offen
    buffer_load_dwordx4 v[72:75], v7, s[16:19], s32 offen
    buffer_load_dwordx4 v[76:79], v8, s[16:19], s32 offen
    buffer_load_dwordx4 v[80:83], v9, s[16:19], s32 offen
    s_mov_b32 s31, 256
    s_mov_b32 s32, 393216
    buffer_load_dwordx4 v[84:87], v2, s[12:15], s31 offen
    buffer_load_dwordx4 v[88:91], v3, s[12:15], s31 offen
    buffer_load_dwordx4 v[92:95], v4, s[12:15], s31 offen
    buffer_load_dwordx4 v[96:99], v5, s[12:15], s31 offen
    buffer_load_dwordx4 v[100:103], v6, s[16:19], s32 offen
    buffer_load_dwordx4 v[104:107], v7, s[16:19], s32 offen
    buffer_load_dwordx4 v[108:111], v8, s[16:19], s32 offen
    buffer_load_dwordx4 v[112:115], v9, s[16:19], s32 offen
    s_waitcnt vmcnt(16)
    ds_write_b128 v10, v[20:23] offset:0
    ds_write_b128 v10, v[24:27] offset:4608
    ds_write_b128 v10, v[28:31] offset:9216
    ds_write_b128 v10, v[32:35] offset:13824
    ds_write_b128 v11, v[36:39] offset:0
    ds_write_b128 v11, v[40:43] offset:5120
    ds_write_b128 v11, v[44:47] offset:10240
    ds_write_b128 v11, v[48:51] offset:15360
    s_waitcnt lgkmcnt(0)
    s_barrier
    s_mov_b32 s31, 384
    s_mov_b32 s32, 589824
    buffer_load_dwordx4 v[20:23], v2, s[12:15], s31 offen
    buffer_load_dwordx4 v[24:27], v3, s[12:15], s31 offen
    buffer_load_dwordx4 v[28:31], v4, s[12:15], s31 offen
    buffer_load_dwordx4 v[32:35], v5, s[12:15], s31 offen
    buffer_load_dwordx4 v[36:39], v6, s[16:19], s32 offen
    buffer_load_dwordx4 v[40:43], v7, s[16:19], s32 offen
    buffer_load_dwordx4 v[44:47], v8, s[16:19], s32 offen
    buffer_load_dwordx4 v[48:51], v9, s[16:19], s32 offen
    ds_read_b128 v[116:119], v12 offset:0
    ds_read_b128 v[120:123], v12 offset:4608
    ds_read_b64_tr_b16 v[132:133], v13 offset:0
    ds_read_b64_tr_b16 v[134:135], v13 offset:1280
    ds_read_b64_tr_b16 v[136:137], v13 offset:64
    ds_read_b64_tr_b16 v[138:139], v13 offset:1344
    ds_read_b128 v[124:127], v12 offset:32
    ds_read_b128 v[128:131], v12 offset:4640
    ds_read_b64_tr_b16 v[140:141], v13 offset:5120
    ds_read_b64_tr_b16 v[142:143], v13 offset:6400
    ds_read_b64_tr_b16 v[144:145], v13 offset:5184
    ds_read_b64_tr_b16 v[146:147], v13 offset:6464
    s_waitcnt lgkmcnt(6)
    v_mfma_f32_32x32x16_bf16 v[148:163], v[132:135], v[116:119], v[148:163]
    v_mfma_f32_32x32x16_bf16 v[164:179], v[136:139], v[116:119], v[164:179]
    v_mfma_f32_32x32x16_bf16 v[180:195], v[132:135], v[120:123], v[180:195]
    v_mfma_f32_32x32x16_bf16 v[196:211], v[136:139], v[120:123], v[196:211]
    ds_read_b128 v[116:119], v12 offset:64
    ds_read_b128 v[120:123], v12 offset:4672
    ds_read_b64_tr_b16 v[132:133], v13 offset:10240
    ds_read_b64_tr_b16 v[134:135], v13 offset:11520
    ds_read_b64_tr_b16 v[136:137], v13 offset:10304
    ds_read_b64_tr_b16 v[138:139], v13 offset:11584
    s_waitcnt lgkmcnt(6)
    v_mfma_f32_32x32x16_bf16 v[148:163], v[140:143], v[124:127], v[148:163]
    v_mfma_f32_32x32x16_bf16 v[164:179], v[144:147], v[124:127], v[164:179]
    v_mfma_f32_32x32x16_bf16 v[180:195], v[140:143], v[128:131], v[180:195]
    v_mfma_f32_32x32x16_bf16 v[196:211], v[144:147], v[128:131], v[196:211]
    ds_read_b128 v[124:127], v12 offset:96
    ds_read_b128 v[128:131], v12 offset:4704
    ds_read_b64_tr_b16 v[140:141], v13 offset:15360
    ds_read_b64_tr_b16 v[142:143], v13 offset:16640
    ds_read_b64_tr_b16 v[144:145], v13 offset:15424
    ds_read_b64_tr_b16 v[146:147], v13 offset:16704
    s_waitcnt lgkmcnt(6)
    v_mfma_f32_32x32x16_bf16 v[148:163], v[132:135], v[116:119], v[148:163]
    v_mfma_f32_32x32x16_bf16 v[164:179], v[136:139], v[116:119], v[164:179]
    v_mfma_f32_32x32x16_bf16 v[180:195], v[132:135], v[120:123], v[180:195]
    v_mfma_f32_32x32x16_bf16 v[196:211], v[136:139], v[120:123], v[196:211]
    s_waitcnt lgkmcnt(0)
    v_mfma_f32_32x32x16_bf16 v[148:163], v[140:143], v[124:127], v[148:163]
    v_mfma_f32_32x32x16_bf16 v[164:179], v[144:147], v[124:127], v[164:179]
    v_mfma_f32_32x32x16_bf16 v[180:195], v[140:143], v[128:131], v[180:195]
    v_mfma_f32_32x32x16_bf16 v[196:211], v[144:147], v[128:131], v[196:211]
    s_waitcnt vmcnt(16)
    ds_write_b128 v10, v[52:55] offset:38912
    ds_write_b128 v10, v[56:59] offset:43520
    ds_write_b128 v10, v[60:63] offset:48128
    ds_write_b128 v10, v[64:67] offset:52736
    ds_write_b128 v11, v[68:71] offset:38912
    ds_write_b128 v11, v[72:75] offset:44032
    ds_write_b128 v11, v[76:79] offset:49152
    ds_write_b128 v11, v[80:83] offset:54272
    s_waitcnt lgkmcnt(0)
    s_barrier
    s_mov_b32 s31, 512
    s_mov_b32 s32, 786432
    buffer_load_dwordx4 v[52:55], v2, s[12:15], s31 offen
    buffer_load_dwordx4 v[56:59], v3, s[12:15], s31 offen
    buffer_load_dwordx4 v[60:63], v4, s[12:15], s31 offen
    buffer_load_dwordx4 v[64:67], v5, s[12:15], s31 offen
    buffer_load_dwordx4 v[68:71], v6, s[16:19], s32 offen
    buffer_load_dwordx4 v[72:75], v7, s[16:19], s32 offen
    buffer_load_dwordx4 v[76:79], v8, s[16:19], s32 offen
    buffer_load_dwordx4 v[80:83], v9, s[16:19], s32 offen
    ds_read_b128 v[116:119], v12 offset:38912
    ds_read_b128 v[120:123], v12 offset:43520
    ds_read_b64_tr_b16 v[132:133], v13 offset:38912
    ds_read_b64_tr_b16 v[134:135], v13 offset:40192
    ds_read_b64_tr_b16 v[136:137], v13 offset:38976
    ds_read_b64_tr_b16 v[138:139], v13 offset:40256
    ds_read_b128 v[124:127], v12 offset:38944
    ds_read_b128 v[128:131], v12 offset:43552
    ds_read_b64_tr_b16 v[140:141], v13 offset:44032
    ds_read_b64_tr_b16 v[142:143], v13 offset:45312
    ds_read_b64_tr_b16 v[144:145], v13 offset:44096
    ds_read_b64_tr_b16 v[146:147], v13 offset:45376
    s_waitcnt lgkmcnt(6)
    v_mfma_f32_32x32x16_bf16 v[148:163], v[132:135], v[116:119], v[148:163]
    v_mfma_f32_32x32x16_bf16 v[164:179], v[136:139], v[116:119], v[164:179]
    v_mfma_f32_32x32x16_bf16 v[180:195], v[132:135], v[120:123], v[180:195]
    v_mfma_f32_32x32x16_bf16 v[196:211], v[136:139], v[120:123], v[196:211]
    ds_read_b128 v[116:119], v12 offset:38976
    ds_read_b128 v[120:123], v12 offset:43584
    ds_read_b64_tr_b16 v[132:133], v13 offset:49152
    ds_read_b64_tr_b16 v[134:135], v13 offset:50432
    ds_read_b64_tr_b16 v[136:137], v13 offset:49216
    ds_read_b64_tr_b16 v[138:139], v13 offset:50496
    s_waitcnt lgkmcnt(6)
    v_mfma_f32_32x32x16_bf16 v[148:163], v[140:143], v[124:127], v[148:163]
    v_mfma_f32_32x32x16_bf16 v[164:179], v[144:147], v[124:127], v[164:179]
    v_mfma_f32_32x32x16_bf16 v[180:195], v[140:143], v[128:131], v[180:195]
    v_mfma_f32_32x32x16_bf16 v[196:211], v[144:147], v[128:131], v[196:211]
    ds_read_b128 v[124:127], v12 offset:39008
    ds_read_b128 v[128:131], v12 offset:43616
    ds_read_b64_tr_b16 v[140:141], v13 offset:54272
    ds_read_b64_tr_b16 v[142:143], v13 offset:55552
    ds_read_b64_tr_b16 v[144:145], v13 offset:54336
    ds_read_b64_tr_b16 v[146:147], v13 offset:55616
    s_waitcnt lgkmcnt(6)
    v_mfma_f32_32x32x16_bf16 v[148:163], v[132:135], v[116:119], v[148:163]
    v_mfma_f32_32x32x16_bf16 v[164:179], v[136:139], v[116:119], v[164:179]
    v_mfma_f32_32x32x16_bf16 v[180:195], v[132:135], v[120:123], v[180:195]
    v_mfma_f32_32x32x16_bf16 v[196:211], v[136:139], v[120:123], v[196:211]
    s_waitcnt lgkmcnt(0)
    v_mfma_f32_32x32x16_bf16 v[148:163], v[140:143], v[124:127], v[148:163]
    v_mfma_f32_32x32x16_bf16 v[164:179], v[144:147], v[124:127], v[164:179]
    v_mfma_f32_32x32x16_bf16 v[180:195], v[140:143], v[128:131], v[180:195]
    v_mfma_f32_32x32x16_bf16 v[196:211], v[144:147], v[128:131], v[196:211]
    s_waitcnt vmcnt(16)
    ds_write_b128 v10, v[84:87] offset:0
    ds_write_b128 v10, v[88:91] offset:4608
    ds_write_b128 v10, v[92:95] offset:9216
    ds_write_b128 v10, v[96:99] offset:13824
    ds_write_b128 v11, v[100:103] offset:0
    ds_write_b128 v11, v[104:107] offset:5120
    ds_write_b128 v11, v[108:111] offset:10240
    ds_write_b128 v11, v[112:115] offset:15360
    s_waitcnt lgkmcnt(0)
    s_barrier
    s_mov_b32 s31, 640
    s_mov_b32 s32, 983040
    buffer_load_dwordx4 v[84:87], v2, s[12:15], s31 offen
    buffer_load_dwordx4 v[88:91], v3, s[12:15], s31 offen
    buffer_load_dwordx4 v[92:95], v4, s[12:15], s31 offen
    buffer_load_dwordx4 v[96:99], v5, s[12:15], s31 offen
    buffer_load_dwordx4 v[100:103], v6, s[16:19], s32 offen
    buffer_load_dwordx4 v[104:107], v7, s[16:19], s32 offen
    buffer_load_dwordx4 v[108:111], v8, s[16:19], s32 offen
    buffer_load_dwordx4 v[112:115], v9, s[16:19], s32 offen
    ds_read_b128 v[116:119], v12 offset:0
    ds_read_b128 v[120:123], v12 offset:4608
    ds_read_b64_tr_b16 v[132:133], v13 offset:0
    ds_read_b64_tr_b16 v[134:135], v13 offset:1280
    ds_read_b64_tr_b16 v[136:137], v13 offset:64
    ds_read_b64_tr_b16 v[138:139], v13 offset:1344
    ds_read_b128 v[124:127], v12 offset:32
    ds_read_b128 v[128:131], v12 offset:4640
    ds_read_b64_tr_b16 v[140:141], v13 offset:5120
    ds_read_b64_tr_b16 v[142:143], v13 offset:6400
    ds_read_b64_tr_b16 v[144:145], v13 offset:5184
    ds_read_b64_tr_b16 v[146:147], v13 offset:6464
    s_waitcnt lgkmcnt(6)
    v_mfma_f32_32x32x16_bf16 v[148:163], v[132:135], v[116:119], v[148:163]
    v_mfma_f32_32x32x16_bf16 v[164:179], v[136:139], v[116:119], v[164:179]
    v_mfma_f32_32x32x16_bf16 v[180:195], v[132:135], v[120:123], v[180:195]
    v_mfma_f32_32x32x16_bf16 v[196:211], v[136:139], v[120:123], v[196:211]
    ds_read_b128 v[116:119], v12 offset:64
    ds_read_b128 v[120:123], v12 offset:4672
    ds_read_b64_tr_b16 v[132:133], v13 offset:10240
    ds_read_b64_tr_b16 v[134:135], v13 offset:11520
    ds_read_b64_tr_b16 v[136:137], v13 offset:10304
    ds_read_b64_tr_b16 v[138:139], v13 offset:11584
    s_waitcnt lgkmcnt(6)
    v_mfma_f32_32x32x16_bf16 v[148:163], v[140:143], v[124:127], v[148:163]
    v_mfma_f32_32x32x16_bf16 v[164:179], v[144:147], v[124:127], v[164:179]
    v_mfma_f32_32x32x16_bf16 v[180:195], v[140:143], v[128:131], v[180:195]
    v_mfma_f32_32x32x16_bf16 v[196:211], v[144:147], v[128:131], v[196:211]
    ds_read_b128 v[124:127], v12 offset:96
    ds_read_b128 v[128:131], v12 offset:4704
    ds_read_b64_tr_b16 v[140:141], v13 offset:15360
    ds_read_b64_tr_b16 v[142:143], v13 offset:16640
    ds_read_b64_tr_b16 v[144:145], v13 offset:15424
    ds_read_b64_tr_b16 v[146:147], v13 offset:16704
    s_waitcnt lgkmcnt(6)
    v_mfma_f32_32x32x16_bf16 v[148:163], v[132:135], v[116:119], v[148:163]
    v_mfma_f32_32x32x16_bf16 v[164:179], v[136:139], v[116:119], v[164:179]
    v_mfma_f32_32x32x16_bf16 v[180:195], v[132:135], v[120:123], v[180:195]
    v_mfma_f32_32x32x16_bf16 v[196:211], v[136:139], v[120:123], v[196:211]
    s_waitcnt lgkmcnt(0)
    v_mfma_f32_32x32x16_bf16 v[148:163], v[140:143], v[124:127], v[148:163]
    v_mfma_f32_32x32x16_bf16 v[164:179], v[144:147], v[124:127], v[164:179]
    v_mfma_f32_32x32x16_bf16 v[180:195], v[140:143], v[128:131], v[180:195]
    v_mfma_f32_32x32x16_bf16 v[196:211], v[144:147], v[128:131], v[196:211]
    s_waitcnt vmcnt(16)
    ds_write_b128 v10, v[20:23] offset:38912
    ds_write_b128 v10, v[24:27] offset:43520
    ds_write_b128 v10, v[28:31] offset:48128
    ds_write_b128 v10, v[32:35] offset:52736
    ds_write_b128 v11, v[36:39] offset:38912
    ds_write_b128 v11, v[40:43] offset:44032
    ds_write_b128 v11, v[44:47] offset:49152
    ds_write_b128 v11, v[48:51] offset:54272
    s_waitcnt lgkmcnt(0)
    s_barrier
    s_mov_b32 s31, 768
    s_mov_b32 s32, 1179648
    buffer_load_dwordx4 v[20:23], v2, s[12:15], s31 offen
    buffer_load_dwordx4 v[24:27], v3, s[12:15], s31 offen
    buffer_load_dwordx4 v[28:31], v4, s[12:15], s31 offen
    buffer_load_dwordx4 v[32:35], v5, s[12:15], s31 offen
    buffer_load_dwordx4 v[36:39], v6, s[16:19], s32 offen
    buffer_load_dwordx4 v[40:43], v7, s[16:19], s32 offen
    buffer_load_dwordx4 v[44:47], v8, s[16:19], s32 offen
    buffer_load_dwordx4 v[48:51], v9, s[16:19], s32 offen
    ds_read_b128 v[116:119], v12 offset:38912
    ds_read_b128 v[120:123], v12 offset:43520
    ds_read_b64_tr_b16 v[132:133], v13 offset:38912
    ds_read_b64_tr_b16 v[134:135], v13 offset:40192
    ds_read_b64_tr_b16 v[136:137], v13 offset:38976
    ds_read_b64_tr_b16 v[138:139], v13 offset:40256
    ds_read_b128 v[124:127], v12 offset:38944
    ds_read_b128 v[128:131], v12 offset:43552
    ds_read_b64_tr_b16 v[140:141], v13 offset:44032
    ds_read_b64_tr_b16 v[142:143], v13 offset:45312
    ds_read_b64_tr_b16 v[144:145], v13 offset:44096
    ds_read_b64_tr_b16 v[146:147], v13 offset:45376
    s_waitcnt lgkmcnt(6)
    v_mfma_f32_32x32x16_bf16 v[148:163], v[132:135], v[116:119], v[148:163]
    v_mfma_f32_32x32x16_bf16 v[164:179], v[136:139], v[116:119], v[164:179]
    v_mfma_f32_32x32x16_bf16 v[180:195], v[132:135], v[120:123], v[180:195]
    v_mfma_f32_32x32x16_bf16 v[196:211], v[136:139], v[120:123], v[196:211]
    ds_read_b128 v[116:119], v12 offset:38976
    ds_read_b128 v[120:123], v12 offset:43584
    ds_read_b64_tr_b16 v[132:133], v13 offset:49152
    ds_read_b64_tr_b16 v[134:135], v13 offset:50432
    ds_read_b64_tr_b16 v[136:137], v13 offset:49216
    ds_read_b64_tr_b16 v[138:139], v13 offset:50496
    s_waitcnt lgkmcnt(6)
    v_mfma_f32_32x32x16_bf16 v[148:163], v[140:143], v[124:127], v[148:163]
    v_mfma_f32_32x32x16_bf16 v[164:179], v[144:147], v[124:127], v[164:179]
    v_mfma_f32_32x32x16_bf16 v[180:195], v[140:143], v[128:131], v[180:195]
    v_mfma_f32_32x32x16_bf16 v[196:211], v[144:147], v[128:131], v[196:211]
    ds_read_b128 v[124:127], v12 offset:39008
    ds_read_b128 v[128:131], v12 offset:43616
    ds_read_b64_tr_b16 v[140:141], v13 offset:54272
    ds_read_b64_tr_b16 v[142:143], v13 offset:55552
    ds_read_b64_tr_b16 v[144:145], v13 offset:54336
    ds_read_b64_tr_b16 v[146:147], v13 offset:55616
    s_waitcnt lgkmcnt(6)
    v_mfma_f32_32x32x16_bf16 v[148:163], v[132:135], v[116:119], v[148:163]
    v_mfma_f32_32x32x16_bf16 v[164:179], v[136:139], v[116:119], v[164:179]
    v_mfma_f32_32x32x16_bf16 v[180:195], v[132:135], v[120:123], v[180:195]
    v_mfma_f32_32x32x16_bf16 v[196:211], v[136:139], v[120:123], v[196:211]
    s_waitcnt lgkmcnt(0)
    v_mfma_f32_32x32x16_bf16 v[148:163], v[140:143], v[124:127], v[148:163]
    v_mfma_f32_32x32x16_bf16 v[164:179], v[144:147], v[124:127], v[164:179]
    v_mfma_f32_32x32x16_bf16 v[180:195], v[140:143], v[128:131], v[180:195]
    v_mfma_f32_32x32x16_bf16 v[196:211], v[144:147], v[128:131], v[196:211]
    s_waitcnt vmcnt(16)
    ds_write_b128 v10, v[52:55] offset:0
    ds_write_b128 v10, v[56:59] offset:4608
    ds_write_b128 v10, v[60:63] offset:9216
    ds_write_b128 v10, v[64:67] offset:13824
    ds_write_b128 v11, v[68:71] offset:0
    ds_write_b128 v11, v[72:75] offset:5120
    ds_write_b128 v11, v[76:79] offset:10240
    ds_write_b128 v11, v[80:83] offset:15360
    s_waitcnt lgkmcnt(0)
    s_barrier
    s_mov_b32 s31, 896
    s_mov_b32 s32, 1376256
    buffer_load_dwordx4 v[52:55], v2, s[12:15], s31 offen
    buffer_load_dwordx4 v[56:59], v3, s[12:15], s31 offen
    buffer_load_dwordx4 v[60:63], v4, s[12:15], s31 offen
    buffer_load_dwordx4 v[64:67], v5, s[12:15], s31 offen
    buffer_load_dwordx4 v[68:71], v6, s[16:19], s32 offen
    buffer_load_dwordx4 v[72:75], v7, s[16:19], s32 offen
    buffer_load_dwordx4 v[76:79], v8, s[16:19], s32 offen
    buffer_load_dwordx4 v[80:83], v9, s[16:19], s32 offen
    ds_read_b128 v[116:119], v12 offset:0
    ds_read_b128 v[120:123], v12 offset:4608
    ds_read_b64_tr_b16 v[132:133], v13 offset:0
    ds_read_b64_tr_b16 v[134:135], v13 offset:1280
    ds_read_b64_tr_b16 v[136:137], v13 offset:64
    ds_read_b64_tr_b16 v[138:139], v13 offset:1344
    ds_read_b128 v[124:127], v12 offset:32
    ds_read_b128 v[128:131], v12 offset:4640
    ds_read_b64_tr_b16 v[140:141], v13 offset:5120
    ds_read_b64_tr_b16 v[142:143], v13 offset:6400
    ds_read_b64_tr_b16 v[144:145], v13 offset:5184
    ds_read_b64_tr_b16 v[146:147], v13 offset:6464
    s_waitcnt lgkmcnt(6)
    v_mfma_f32_32x32x16_bf16 v[148:163], v[132:135], v[116:119], v[148:163]
    v_mfma_f32_32x32x16_bf16 v[164:179], v[136:139], v[116:119], v[164:179]
    v_mfma_f32_32x32x16_bf16 v[180:195], v[132:135], v[120:123], v[180:195]
    v_mfma_f32_32x32x16_bf16 v[196:211], v[136:139], v[120:123], v[196:211]
    ds_read_b128 v[116:119], v12 offset:64
    ds_read_b128 v[120:123], v12 offset:4672
    ds_read_b64_tr_b16 v[132:133], v13 offset:10240
    ds_read_b64_tr_b16 v[134:135], v13 offset:11520
    ds_read_b64_tr_b16 v[136:137], v13 offset:10304
    ds_read_b64_tr_b16 v[138:139], v13 offset:11584
    s_waitcnt lgkmcnt(6)
    v_mfma_f32_32x32x16_bf16 v[148:163], v[140:143], v[124:127], v[148:163]
    v_mfma_f32_32x32x16_bf16 v[164:179], v[144:147], v[124:127], v[164:179]
    v_mfma_f32_32x32x16_bf16 v[180:195], v[140:143], v[128:131], v[180:195]
    v_mfma_f32_32x32x16_bf16 v[196:211], v[144:147], v[128:131], v[196:211]
    ds_read_b128 v[124:127], v12 offset:96
    ds_read_b128 v[128:131], v12 offset:4704
    ds_read_b64_tr_b16 v[140:141], v13 offset:15360
    ds_read_b64_tr_b16 v[142:143], v13 offset:16640
    ds_read_b64_tr_b16 v[144:145], v13 offset:15424
    ds_read_b64_tr_b16 v[146:147], v13 offset:16704
    s_waitcnt lgkmcnt(6)
    v_mfma_f32_32x32x16_bf16 v[148:163], v[132:135], v[116:119], v[148:163]
    v_mfma_f32_32x32x16_bf16 v[164:179], v[136:139], v[116:119], v[164:179]
    v_mfma_f32_32x32x16_bf16 v[180:195], v[132:135], v[120:123], v[180:195]
    v_mfma_f32_32x32x16_bf16 v[196:211], v[136:139], v[120:123], v[196:211]
    s_waitcnt lgkmcnt(0)
    v_mfma_f32_32x32x16_bf16 v[148:163], v[140:143], v[124:127], v[148:163]
    v_mfma_f32_32x32x16_bf16 v[164:179], v[144:147], v[124:127], v[164:179]
    v_mfma_f32_32x32x16_bf16 v[180:195], v[140:143], v[128:131], v[180:195]
    v_mfma_f32_32x32x16_bf16 v[196:211], v[144:147], v[128:131], v[196:211]
    s_waitcnt vmcnt(16)
    ds_write_b128 v10, v[84:87] offset:38912
    ds_write_b128 v10, v[88:91] offset:43520
    ds_write_b128 v10, v[92:95] offset:48128
    ds_write_b128 v10, v[96:99] offset:52736
    ds_write_b128 v11, v[100:103] offset:38912
    ds_write_b128 v11, v[104:107] offset:44032
    ds_write_b128 v11, v[108:111] offset:49152
    ds_write_b128 v11, v[112:115] offset:54272
    s_waitcnt lgkmcnt(0)
    s_barrier
    ds_read_b128 v[116:119], v12 offset:38912
    ds_read_b128 v[120:123], v12 offset:43520
    ds_read_b64_tr_b16 v[132:133], v13 offset:38912
    ds_read_b64_tr_b16 v[134:135], v13 offset:40192
    ds_read_b64_tr_b16 v[136:137], v13 offset:38976
    ds_read_b64_tr_b16 v[138:139], v13 offset:40256
    ds_read_b128 v[124:127], v12 offset:38944
    ds_read_b128 v[128:131], v12 offset:43552
    ds_read_b64_tr_b16 v[140:141], v13 offset:44032
    ds_read_b64_tr_b16 v[142:143], v13 offset:45312
    ds_read_b64_tr_b16 v[144:145], v13 offset:44096
    ds_read_b64_tr_b16 v[146:147], v13 offset:45376
    s_waitcnt lgkmcnt(6)
    v_mfma_f32_32x32x16_bf16 v[148:163], v[132:135], v[116:119], v[148:163]
    v_mfma_f32_32x32x16_bf16 v[164:179], v[136:139], v[116:119], v[164:179]
    v_mfma_f32_32x32x16_bf16 v[180:195], v[132:135], v[120:123], v[180:195]
    v_mfma_f32_32x32x16_bf16 v[196:211], v[136:139], v[120:123], v[196:211]
    ds_read_b128 v[116:119], v12 offset:38976
    ds_read_b128 v[120:123], v12 offset:43584
    ds_read_b64_tr_b16 v[132:133], v13 offset:49152
    ds_read_b64_tr_b16 v[134:135], v13 offset:50432
    ds_read_b64_tr_b16 v[136:137], v13 offset:49216
    ds_read_b64_tr_b16 v[138:139], v13 offset:50496
    s_waitcnt lgkmcnt(6)
    v_mfma_f32_32x32x16_bf16 v[148:163], v[140:143], v[124:127], v[148:163]
    v_mfma_f32_32x32x16_bf16 v[164:179], v[144:147], v[124:127], v[164:179]
    v_mfma_f32_32x32x16_bf16 v[180:195], v[140:143], v[128:131], v[180:195]
    v_mfma_f32_32x32x16_bf16 v[196:211], v[144:147], v[128:131], v[196:211]
    ds_read_b128 v[124:127], v12 offset:39008
    ds_read_b128 v[128:131], v12 offset:43616
    ds_read_b64_tr_b16 v[140:141], v13 offset:54272
    ds_read_b64_tr_b16 v[142:143], v13 offset:55552
    ds_read_b64_tr_b16 v[144:145], v13 offset:54336
    ds_read_b64_tr_b16 v[146:147], v13 offset:55616
    s_waitcnt lgkmcnt(6)
    v_mfma_f32_32x32x16_bf16 v[148:163], v[132:135], v[116:119], v[148:163]
    v_mfma_f32_32x32x16_bf16 v[164:179], v[136:139], v[116:119], v[164:179]
    v_mfma_f32_32x32x16_bf16 v[180:195], v[132:135], v[120:123], v[180:195]
    v_mfma_f32_32x32x16_bf16 v[196:211], v[136:139], v[120:123], v[196:211]
    s_waitcnt lgkmcnt(0)
    v_mfma_f32_32x32x16_bf16 v[148:163], v[140:143], v[124:127], v[148:163]
    v_mfma_f32_32x32x16_bf16 v[164:179], v[144:147], v[124:127], v[164:179]
    v_mfma_f32_32x32x16_bf16 v[180:195], v[140:143], v[128:131], v[180:195]
    v_mfma_f32_32x32x16_bf16 v[196:211], v[144:147], v[128:131], v[196:211]
    s_waitcnt vmcnt(8)
    ds_write_b128 v10, v[20:23] offset:0
    ds_write_b128 v10, v[24:27] offset:4608
    ds_write_b128 v10, v[28:31] offset:9216
    ds_write_b128 v10, v[32:35] offset:13824
    ds_write_b128 v11, v[36:39] offset:0
    ds_write_b128 v11, v[40:43] offset:5120
    ds_write_b128 v11, v[44:47] offset:10240
    ds_write_b128 v11, v[48:51] offset:15360
    s_waitcnt lgkmcnt(0)
    s_barrier
    ds_read_b128 v[116:119], v12 offset:0
    ds_read_b128 v[120:123], v12 offset:4608
    ds_read_b64_tr_b16 v[132:133], v13 offset:0
    ds_read_b64_tr_b16 v[134:135], v13 offset:1280
    ds_read_b64_tr_b16 v[136:137], v13 offset:64
    ds_read_b64_tr_b16 v[138:139], v13 offset:1344
    ds_read_b128 v[124:127], v12 offset:32
    ds_read_b128 v[128:131], v12 offset:4640
    ds_read_b64_tr_b16 v[140:141], v13 offset:5120
    ds_read_b64_tr_b16 v[142:143], v13 offset:6400
    ds_read_b64_tr_b16 v[144:145], v13 offset:5184
    ds_read_b64_tr_b16 v[146:147], v13 offset:6464
    s_waitcnt lgkmcnt(6)
    v_mfma_f32_32x32x16_bf16 v[148:163], v[132:135], v[116:119], v[148:163]
    v_mfma_f32_32x32x16_bf16 v[164:179], v[136:139], v[116:119], v[164:179]
    v_mfma_f32_32x32x16_bf16 v[180:195], v[132:135], v[120:123], v[180:195]
    v_mfma_f32_32x32x16_bf16 v[196:211], v[136:139], v[120:123], v[196:211]
    ds_read_b128 v[116:119], v12 offset:64
    ds_read_b128 v[120:123], v12 offset:4672
    ds_read_b64_tr_b16 v[132:133], v13 offset:10240
    ds_read_b64_tr_b16 v[134:135], v13 offset:11520
    ds_read_b64_tr_b16 v[136:137], v13 offset:10304
    ds_read_b64_tr_b16 v[138:139], v13 offset:11584
    s_waitcnt lgkmcnt(6)
    v_mfma_f32_32x32x16_bf16 v[148:163], v[140:143], v[124:127], v[148:163]
    v_mfma_f32_32x32x16_bf16 v[164:179], v[144:147], v[124:127], v[164:179]
    v_mfma_f32_32x32x16_bf16 v[180:195], v[140:143], v[128:131], v[180:195]
    v_mfma_f32_32x32x16_bf16 v[196:211], v[144:147], v[128:131], v[196:211]
    ds_read_b128 v[124:127], v12 offset:96
    ds_read_b128 v[128:131], v12 offset:4704
    ds_read_b64_tr_b16 v[140:141], v13 offset:15360
    ds_read_b64_tr_b16 v[142:143], v13 offset:16640
    ds_read_b64_tr_b16 v[144:145], v13 offset:15424
    ds_read_b64_tr_b16 v[146:147], v13 offset:16704
    s_waitcnt lgkmcnt(6)
    v_mfma_f32_32x32x16_bf16 v[148:163], v[132:135], v[116:119], v[148:163]
    v_mfma_f32_32x32x16_bf16 v[164:179], v[136:139], v[116:119], v[164:179]
    v_mfma_f32_32x32x16_bf16 v[180:195], v[132:135], v[120:123], v[180:195]
    v_mfma_f32_32x32x16_bf16 v[196:211], v[136:139], v[120:123], v[196:211]
    s_waitcnt lgkmcnt(0)
    v_mfma_f32_32x32x16_bf16 v[148:163], v[140:143], v[124:127], v[148:163]
    v_mfma_f32_32x32x16_bf16 v[164:179], v[144:147], v[124:127], v[164:179]
    v_mfma_f32_32x32x16_bf16 v[180:195], v[140:143], v[128:131], v[180:195]
    v_mfma_f32_32x32x16_bf16 v[196:211], v[144:147], v[128:131], v[196:211]
    s_waitcnt vmcnt(0)
    ds_write_b128 v10, v[52:55] offset:38912
    ds_write_b128 v10, v[56:59] offset:43520
    ds_write_b128 v10, v[60:63] offset:48128
    ds_write_b128 v10, v[64:67] offset:52736
    ds_write_b128 v11, v[68:71] offset:38912
    ds_write_b128 v11, v[72:75] offset:44032
    ds_write_b128 v11, v[76:79] offset:49152
    ds_write_b128 v11, v[80:83] offset:54272
    s_waitcnt lgkmcnt(0)
    s_barrier
    ds_read_b128 v[116:119], v12 offset:38912
    ds_read_b128 v[120:123], v12 offset:43520
    ds_read_b64_tr_b16 v[132:133], v13 offset:38912
    ds_read_b64_tr_b16 v[134:135], v13 offset:40192
    ds_read_b64_tr_b16 v[136:137], v13 offset:38976
    ds_read_b64_tr_b16 v[138:139], v13 offset:40256
    ds_read_b128 v[124:127], v12 offset:38944
    ds_read_b128 v[128:131], v12 offset:43552
    ds_read_b64_tr_b16 v[140:141], v13 offset:44032
    ds_read_b64_tr_b16 v[142:143], v13 offset:45312
    ds_read_b64_tr_b16 v[144:145], v13 offset:44096
    ds_read_b64_tr_b16 v[146:147], v13 offset:45376
    s_waitcnt lgkmcnt(6)
    v_mfma_f32_32x32x16_bf16 v[148:163], v[132:135], v[116:119], v[148:163]
    v_mfma_f32_32x32x16_bf16 v[164:179], v[136:139], v[116:119], v[164:179]
    v_mfma_f32_32x32x16_bf16 v[180:195], v[132:135], v[120:123], v[180:195]
    v_mfma_f32_32x32x16_bf16 v[196:211], v[136:139], v[120:123], v[196:211]
    ds_read_b128 v[116:119], v12 offset:38976
    ds_read_b128 v[120:123], v12 offset:43584
    ds_read_b64_tr_b16 v[132:133], v13 offset:49152
    ds_read_b64_tr_b16 v[134:135], v13 offset:50432
    ds_read_b64_tr_b16 v[136:137], v13 offset:49216
    ds_read_b64_tr_b16 v[138:139], v13 offset:50496
    s_waitcnt lgkmcnt(6)
    v_mfma_f32_32x32x16_bf16 v[148:163], v[140:143], v[124:127], v[148:163]
    v_mfma_f32_32x32x16_bf16 v[164:179], v[144:147], v[124:127], v[164:179]
    v_mfma_f32_32x32x16_bf16 v[180:195], v[140:143], v[128:131], v[180:195]
    v_mfma_f32_32x32x16_bf16 v[196:211], v[144:147], v[128:131], v[196:211]
    ds_read_b128 v[124:127], v12 offset:39008
    ds_read_b128 v[128:131], v12 offset:43616
    ds_read_b64_tr_b16 v[140:141], v13 offset:54272
    ds_read_b64_tr_b16 v[142:143], v13 offset:55552
    ds_read_b64_tr_b16 v[144:145], v13 offset:54336
    ds_read_b64_tr_b16 v[146:147], v13 offset:55616
    s_waitcnt lgkmcnt(6)
    v_mfma_f32_32x32x16_bf16 v[148:163], v[132:135], v[116:119], v[148:163]
    v_mfma_f32_32x32x16_bf16 v[164:179], v[136:139], v[116:119], v[164:179]
    v_mfma_f32_32x32x16_bf16 v[180:195], v[132:135], v[120:123], v[180:195]
    v_mfma_f32_32x32x16_bf16 v[196:211], v[136:139], v[120:123], v[196:211]
    s_waitcnt lgkmcnt(0)
    v_mfma_f32_32x32x16_bf16 v[148:163], v[140:143], v[124:127], v[148:163]
    v_mfma_f32_32x32x16_bf16 v[164:179], v[144:147], v[124:127], v[164:179]
    v_mfma_f32_32x32x16_bf16 v[180:195], v[140:143], v[128:131], v[180:195]
    v_mfma_f32_32x32x16_bf16 v[196:211], v[144:147], v[128:131], v[196:211]
    s_nop 15
    s_nop 3
    v_and_b32 v14, 31, v1
    s_lshl_b32 s29, s24, 7
    s_mul_i32 s30, s28, 64
    s_add_u32 s29, s29, s30
    v_add_u32 v14, s29, v14
    v_lshlrev_b32 v14, 5, v14
    v_lshrrev_b32 v15, 5, v1
    v_lshl_add_u32 v14, v15, 3, v14
    s_lshr_b32 s29, s25, 2
    s_lshl_b32 s29, s29, 21
    s_and_b32 s30, s25, 3
    s_lshl_b32 s30, s30, 3
    s_lshl_b32 s31, s27, 2
    s_add_u32 s30, s30, s31
    s_lshl_b32 s30, s30, 16
    s_add_u32 s29, s29, s30

    s_add_u32 s33, s29, 0
    v_cvt_pk_bf16_f32 v20, v148, v149
    v_cvt_pk_bf16_f32 v21, v150, v151
    buffer_store_dwordx2 v[20:21], v14, s[20:23], s33 offen offset:0
    s_nop 1
    s_add_u32 s33, s29, 0
    v_cvt_pk_bf16_f32 v20, v152, v153
    v_cvt_pk_bf16_f32 v21, v154, v155
    buffer_store_dwordx2 v[20:21], v14, s[20:23], s33 offen offset:16
    s_nop 1
    s_add_u32 s33, s29, 65536
    v_cvt_pk_bf16_f32 v20, v156, v157
    v_cvt_pk_bf16_f32 v21, v158, v159
    buffer_store_dwordx2 v[20:21], v14, s[20:23], s33 offen offset:0
    s_nop 1
    s_add_u32 s33, s29, 65536
    v_cvt_pk_bf16_f32 v20, v160, v161
    v_cvt_pk_bf16_f32 v21, v162, v163
    buffer_store_dwordx2 v[20:21], v14, s[20:23], s33 offen offset:16
    s_nop 1
    s_add_u32 s33, s29, 131072
    v_cvt_pk_bf16_f32 v20, v164, v165
    v_cvt_pk_bf16_f32 v21, v166, v167
    buffer_store_dwordx2 v[20:21], v14, s[20:23], s33 offen offset:0
    s_nop 1
    s_add_u32 s33, s29, 131072
    v_cvt_pk_bf16_f32 v20, v168, v169
    v_cvt_pk_bf16_f32 v21, v170, v171
    buffer_store_dwordx2 v[20:21], v14, s[20:23], s33 offen offset:16
    s_nop 1
    s_add_u32 s33, s29, 196608
    v_cvt_pk_bf16_f32 v20, v172, v173
    v_cvt_pk_bf16_f32 v21, v174, v175
    buffer_store_dwordx2 v[20:21], v14, s[20:23], s33 offen offset:0
    s_nop 1
    s_add_u32 s33, s29, 196608
    v_cvt_pk_bf16_f32 v20, v176, v177
    v_cvt_pk_bf16_f32 v21, v178, v179
    buffer_store_dwordx2 v[20:21], v14, s[20:23], s33 offen offset:16
    s_nop 1
    s_add_u32 s33, s29, 1024
    v_cvt_pk_bf16_f32 v20, v180, v181
    v_cvt_pk_bf16_f32 v21, v182, v183
    buffer_store_dwordx2 v[20:21], v14, s[20:23], s33 offen offset:0
    s_nop 1
    s_add_u32 s33, s29, 1024
    v_cvt_pk_bf16_f32 v20, v184, v185
    v_cvt_pk_bf16_f32 v21, v186, v187
    buffer_store_dwordx2 v[20:21], v14, s[20:23], s33 offen offset:16
    s_nop 1
    s_add_u32 s33, s29, 66560
    v_cvt_pk_bf16_f32 v20, v188, v189
    v_cvt_pk_bf16_f32 v21, v190, v191
    buffer_store_dwordx2 v[20:21], v14, s[20:23], s33 offen offset:0
    s_nop 1
    s_add_u32 s33, s29, 66560
    v_cvt_pk_bf16_f32 v20, v192, v193
    v_cvt_pk_bf16_f32 v21, v194, v195
    buffer_store_dwordx2 v[20:21], v14, s[20:23], s33 offen offset:16
    s_nop 1
    s_add_u32 s33, s29, 132096
    v_cvt_pk_bf16_f32 v20, v196, v197
    v_cvt_pk_bf16_f32 v21, v198, v199
    buffer_store_dwordx2 v[20:21], v14, s[20:23], s33 offen offset:0
    s_nop 1
    s_add_u32 s33, s29, 132096
    v_cvt_pk_bf16_f32 v20, v200, v201
    v_cvt_pk_bf16_f32 v21, v202, v203
    buffer_store_dwordx2 v[20:21], v14, s[20:23], s33 offen offset:16
    s_nop 1
    s_add_u32 s33, s29, 197632
    v_cvt_pk_bf16_f32 v20, v204, v205
    v_cvt_pk_bf16_f32 v21, v206, v207
    buffer_store_dwordx2 v[20:21], v14, s[20:23], s33 offen offset:0
    s_nop 1
    s_add_u32 s33, s29, 197632
    v_cvt_pk_bf16_f32 v20, v208, v209
    v_cvt_pk_bf16_f32 v21, v210, v211
    buffer_store_dwordx2 v[20:21], v14, s[20:23], s33 offen offset:16
    s_nop 1
    s_branch Le_3
Lv_2:
    v_mov_b32 v148, 0
    v_mov_b32 v149, 0
    v_mov_b32 v150, 0
    v_mov_b32 v151, 0
    v_mov_b32 v152, 0
    v_mov_b32 v153, 0
    v_mov_b32 v154, 0
    v_mov_b32 v155, 0
    v_mov_b32 v156, 0
    v_mov_b32 v157, 0
    v_mov_b32 v158, 0
    v_mov_b32 v159, 0
    v_mov_b32 v160, 0
    v_mov_b32 v161, 0
    v_mov_b32 v162, 0
    v_mov_b32 v163, 0
    v_mov_b32 v164, 0
    v_mov_b32 v165, 0
    v_mov_b32 v166, 0
    v_mov_b32 v167, 0
    v_mov_b32 v168, 0
    v_mov_b32 v169, 0
    v_mov_b32 v170, 0
    v_mov_b32 v171, 0
    v_mov_b32 v172, 0
    v_mov_b32 v173, 0
    v_mov_b32 v174, 0
    v_mov_b32 v175, 0
    v_mov_b32 v176, 0
    v_mov_b32 v177, 0
    v_mov_b32 v178, 0
    v_mov_b32 v179, 0
    v_mov_b32 v180, 0
    v_mov_b32 v181, 0
    v_mov_b32 v182, 0
    v_mov_b32 v183, 0
    v_mov_b32 v184, 0
    v_mov_b32 v185, 0
    v_mov_b32 v186, 0
    v_mov_b32 v187, 0
    v_mov_b32 v188, 0
    v_mov_b32 v189, 0
    v_mov_b32 v190, 0
    v_mov_b32 v191, 0
    v_mov_b32 v192, 0
    v_mov_b32 v193, 0
    v_mov_b32 v194, 0
    v_mov_b32 v195, 0
    v_mov_b32 v196, 0
    v_mov_b32 v197, 0
    v_mov_b32 v198, 0
    v_mov_b32 v199, 0
    v_mov_b32 v200, 0
    v_mov_b32 v201, 0
    v_mov_b32 v202, 0
    v_mov_b32 v203, 0
    v_mov_b32 v204, 0
    v_mov_b32 v205, 0
    v_mov_b32 v206, 0
    v_mov_b32 v207, 0
    v_mov_b32 v208, 0
    v_mov_b32 v209, 0
    v_mov_b32 v210, 0
    v_mov_b32 v211, 0
    s_mov_b32 s31, 0
    s_mov_b32 s32, 0
    buffer_load_dwordx4 v[20:23], v2, s[12:15], s31 offen
    buffer_load_dwordx4 v[24:27], v3, s[12:15], s31 offen
    buffer_load_dwordx4 v[28:31], v4, s[12:15], s31 offen
    buffer_load_dwordx4 v[32:35], v5, s[12:15], s31 offen
    buffer_load_dwordx4 v[36:39], v6, s[16:19], s32 offen
    buffer_load_dwordx4 v[40:43], v7, s[16:19], s32 offen
    buffer_load_dwordx4 v[44:47], v8, s[16:19], s32 offen
    buffer_load_dwordx4 v[48:51], v9, s[16:19], s32 offen
    s_mov_b32 s31, 128
    s_mov_b32 s32, 196608
    buffer_load_dwordx4 v[52:55], v2, s[12:15], s31 offen
    buffer_load_dwordx4 v[56:59], v3, s[12:15], s31 offen
    buffer_load_dwordx4 v[60:63], v4, s[12:15], s31 offen
    buffer_load_dwordx4 v[64:67], v5, s[12:15], s31 offen
    buffer_load_dwordx4 v[68:71], v6, s[16:19], s32 offen
    buffer_load_dwordx4 v[72:75], v7, s[16:19], s32 offen
    buffer_load_dwordx4 v[76:79], v8, s[16:19], s32 offen
    buffer_load_dwordx4 v[80:83], v9, s[16:19], s32 offen
    s_mov_b32 s31, 256
    s_mov_b32 s32, 393216
    buffer_load_dwordx4 v[84:87], v2, s[12:15], s31 offen
    buffer_load_dwordx4 v[88:91], v3, s[12:15], s31 offen
    buffer_load_dwordx4 v[92:95], v4, s[12:15], s31 offen
    buffer_load_dwordx4 v[96:99], v5, s[12:15], s31 offen
    buffer_load_dwordx4 v[100:103], v6, s[16:19], s32 offen
    buffer_load_dwordx4 v[104:107], v7, s[16:19], s32 offen
    buffer_load_dwordx4 v[108:111], v8, s[16:19], s32 offen
    buffer_load_dwordx4 v[112:115], v9, s[16:19], s32 offen
    s_waitcnt vmcnt(16)
    ds_write_b128 v10, v[20:23] offset:0
    ds_write_b128 v10, v[24:27] offset:4608
    ds_write_b128 v10, v[28:31] offset:9216
    ds_write_b128 v10, v[32:35] offset:13824
    ds_write_b128 v11, v[36:39] offset:0
    ds_write_b128 v11, v[40:43] offset:5120
    ds_write_b128 v11, v[44:47] offset:10240
    ds_write_b128 v11, v[48:51] offset:15360
    s_waitcnt lgkmcnt(0)
    s_barrier
    s_mov_b32 s31, 384
    s_mov_b32 s32, 589824
    buffer_load_dwordx4 v[20:23], v2, s[12:15], s31 offen
    buffer_load_dwordx4 v[24:27], v3, s[12:15], s31 offen
    buffer_load_dwordx4 v[28:31], v4, s[12:15], s31 offen
    buffer_load_dwordx4 v[32:35], v5, s[12:15], s31 offen
    buffer_load_dwordx4 v[36:39], v6, s[16:19], s32 offen
    buffer_load_dwordx4 v[40:43], v7, s[16:19], s32 offen
    buffer_load_dwordx4 v[44:47], v8, s[16:19], s32 offen
    buffer_load_dwordx4 v[48:51], v9, s[16:19], s32 offen
    ds_read_b128 v[116:119], v12 offset:0
    ds_read_b128 v[120:123], v12 offset:4608
    ds_read_b64_tr_b16 v[132:133], v13 offset:0
    ds_read_b64_tr_b16 v[134:135], v13 offset:1280
    ds_read_b64_tr_b16 v[136:137], v13 offset:64
    ds_read_b64_tr_b16 v[138:139], v13 offset:1344
    ds_read_b128 v[124:127], v12 offset:32
    ds_read_b128 v[128:131], v12 offset:4640
    ds_read_b64_tr_b16 v[140:141], v13 offset:5120
    ds_read_b64_tr_b16 v[142:143], v13 offset:6400
    ds_read_b64_tr_b16 v[144:145], v13 offset:5184
    ds_read_b64_tr_b16 v[146:147], v13 offset:6464
    s_waitcnt lgkmcnt(6)
    v_mfma_f32_32x32x16_bf16 v[148:163], v[116:119], v[132:135], v[148:163]
    v_mfma_f32_32x32x16_bf16 v[164:179], v[116:119], v[136:139], v[164:179]
    v_mfma_f32_32x32x16_bf16 v[180:195], v[120:123], v[132:135], v[180:195]
    v_mfma_f32_32x32x16_bf16 v[196:211], v[120:123], v[136:139], v[196:211]
    ds_read_b128 v[116:119], v12 offset:64
    ds_read_b128 v[120:123], v12 offset:4672
    ds_read_b64_tr_b16 v[132:133], v13 offset:10240
    ds_read_b64_tr_b16 v[134:135], v13 offset:11520
    ds_read_b64_tr_b16 v[136:137], v13 offset:10304
    ds_read_b64_tr_b16 v[138:139], v13 offset:11584
    s_waitcnt lgkmcnt(6)
    v_mfma_f32_32x32x16_bf16 v[148:163], v[124:127], v[140:143], v[148:163]
    v_mfma_f32_32x32x16_bf16 v[164:179], v[124:127], v[144:147], v[164:179]
    v_mfma_f32_32x32x16_bf16 v[180:195], v[128:131], v[140:143], v[180:195]
    v_mfma_f32_32x32x16_bf16 v[196:211], v[128:131], v[144:147], v[196:211]
    ds_read_b128 v[124:127], v12 offset:96
    ds_read_b128 v[128:131], v12 offset:4704
    ds_read_b64_tr_b16 v[140:141], v13 offset:15360
    ds_read_b64_tr_b16 v[142:143], v13 offset:16640
    ds_read_b64_tr_b16 v[144:145], v13 offset:15424
    ds_read_b64_tr_b16 v[146:147], v13 offset:16704
    s_waitcnt lgkmcnt(6)
    v_mfma_f32_32x32x16_bf16 v[148:163], v[116:119], v[132:135], v[148:163]
    v_mfma_f32_32x32x16_bf16 v[164:179], v[116:119], v[136:139], v[164:179]
    v_mfma_f32_32x32x16_bf16 v[180:195], v[120:123], v[132:135], v[180:195]
    v_mfma_f32_32x32x16_bf16 v[196:211], v[120:123], v[136:139], v[196:211]
    s_waitcnt lgkmcnt(0)
    v_mfma_f32_32x32x16_bf16 v[148:163], v[124:127], v[140:143], v[148:163]
    v_mfma_f32_32x32x16_bf16 v[164:179], v[124:127], v[144:147], v[164:179]
    v_mfma_f32_32x32x16_bf16 v[180:195], v[128:131], v[140:143], v[180:195]
    v_mfma_f32_32x32x16_bf16 v[196:211], v[128:131], v[144:147], v[196:211]
    s_waitcnt vmcnt(16)
    ds_write_b128 v10, v[52:55] offset:38912
    ds_write_b128 v10, v[56:59] offset:43520
    ds_write_b128 v10, v[60:63] offset:48128
    ds_write_b128 v10, v[64:67] offset:52736
    ds_write_b128 v11, v[68:71] offset:38912
    ds_write_b128 v11, v[72:75] offset:44032
    ds_write_b128 v11, v[76:79] offset:49152
    ds_write_b128 v11, v[80:83] offset:54272
    s_waitcnt lgkmcnt(0)
    s_barrier
    s_mov_b32 s31, 512
    s_mov_b32 s32, 786432
    buffer_load_dwordx4 v[52:55], v2, s[12:15], s31 offen
    buffer_load_dwordx4 v[56:59], v3, s[12:15], s31 offen
    buffer_load_dwordx4 v[60:63], v4, s[12:15], s31 offen
    buffer_load_dwordx4 v[64:67], v5, s[12:15], s31 offen
    buffer_load_dwordx4 v[68:71], v6, s[16:19], s32 offen
    buffer_load_dwordx4 v[72:75], v7, s[16:19], s32 offen
    buffer_load_dwordx4 v[76:79], v8, s[16:19], s32 offen
    buffer_load_dwordx4 v[80:83], v9, s[16:19], s32 offen
    ds_read_b128 v[116:119], v12 offset:38912
    ds_read_b128 v[120:123], v12 offset:43520
    ds_read_b64_tr_b16 v[132:133], v13 offset:38912
    ds_read_b64_tr_b16 v[134:135], v13 offset:40192
    ds_read_b64_tr_b16 v[136:137], v13 offset:38976
    ds_read_b64_tr_b16 v[138:139], v13 offset:40256
    ds_read_b128 v[124:127], v12 offset:38944
    ds_read_b128 v[128:131], v12 offset:43552
    ds_read_b64_tr_b16 v[140:141], v13 offset:44032
    ds_read_b64_tr_b16 v[142:143], v13 offset:45312
    ds_read_b64_tr_b16 v[144:145], v13 offset:44096
    ds_read_b64_tr_b16 v[146:147], v13 offset:45376
    s_waitcnt lgkmcnt(6)
    v_mfma_f32_32x32x16_bf16 v[148:163], v[116:119], v[132:135], v[148:163]
    v_mfma_f32_32x32x16_bf16 v[164:179], v[116:119], v[136:139], v[164:179]
    v_mfma_f32_32x32x16_bf16 v[180:195], v[120:123], v[132:135], v[180:195]
    v_mfma_f32_32x32x16_bf16 v[196:211], v[120:123], v[136:139], v[196:211]
    ds_read_b128 v[116:119], v12 offset:38976
    ds_read_b128 v[120:123], v12 offset:43584
    ds_read_b64_tr_b16 v[132:133], v13 offset:49152
    ds_read_b64_tr_b16 v[134:135], v13 offset:50432
    ds_read_b64_tr_b16 v[136:137], v13 offset:49216
    ds_read_b64_tr_b16 v[138:139], v13 offset:50496
    s_waitcnt lgkmcnt(6)
    v_mfma_f32_32x32x16_bf16 v[148:163], v[124:127], v[140:143], v[148:163]
    v_mfma_f32_32x32x16_bf16 v[164:179], v[124:127], v[144:147], v[164:179]
    v_mfma_f32_32x32x16_bf16 v[180:195], v[128:131], v[140:143], v[180:195]
    v_mfma_f32_32x32x16_bf16 v[196:211], v[128:131], v[144:147], v[196:211]
    ds_read_b128 v[124:127], v12 offset:39008
    ds_read_b128 v[128:131], v12 offset:43616
    ds_read_b64_tr_b16 v[140:141], v13 offset:54272
    ds_read_b64_tr_b16 v[142:143], v13 offset:55552
    ds_read_b64_tr_b16 v[144:145], v13 offset:54336
    ds_read_b64_tr_b16 v[146:147], v13 offset:55616
    s_waitcnt lgkmcnt(6)
    v_mfma_f32_32x32x16_bf16 v[148:163], v[116:119], v[132:135], v[148:163]
    v_mfma_f32_32x32x16_bf16 v[164:179], v[116:119], v[136:139], v[164:179]
    v_mfma_f32_32x32x16_bf16 v[180:195], v[120:123], v[132:135], v[180:195]
    v_mfma_f32_32x32x16_bf16 v[196:211], v[120:123], v[136:139], v[196:211]
    s_waitcnt lgkmcnt(0)
    v_mfma_f32_32x32x16_bf16 v[148:163], v[124:127], v[140:143], v[148:163]
    v_mfma_f32_32x32x16_bf16 v[164:179], v[124:127], v[144:147], v[164:179]
    v_mfma_f32_32x32x16_bf16 v[180:195], v[128:131], v[140:143], v[180:195]
    v_mfma_f32_32x32x16_bf16 v[196:211], v[128:131], v[144:147], v[196:211]
    s_waitcnt vmcnt(16)
    ds_write_b128 v10, v[84:87] offset:0
    ds_write_b128 v10, v[88:91] offset:4608
    ds_write_b128 v10, v[92:95] offset:9216
    ds_write_b128 v10, v[96:99] offset:13824
    ds_write_b128 v11, v[100:103] offset:0
    ds_write_b128 v11, v[104:107] offset:5120
    ds_write_b128 v11, v[108:111] offset:10240
    ds_write_b128 v11, v[112:115] offset:15360
    s_waitcnt lgkmcnt(0)
    s_barrier
    s_mov_b32 s31, 640
    s_mov_b32 s32, 983040
    buffer_load_dwordx4 v[84:87], v2, s[12:15], s31 offen
    buffer_load_dwordx4 v[88:91], v3, s[12:15], s31 offen
    buffer_load_dwordx4 v[92:95], v4, s[12:15], s31 offen
    buffer_load_dwordx4 v[96:99], v5, s[12:15], s31 offen
    buffer_load_dwordx4 v[100:103], v6, s[16:19], s32 offen
    buffer_load_dwordx4 v[104:107], v7, s[16:19], s32 offen
    buffer_load_dwordx4 v[108:111], v8, s[16:19], s32 offen
    buffer_load_dwordx4 v[112:115], v9, s[16:19], s32 offen
    ds_read_b128 v[116:119], v12 offset:0
    ds_read_b128 v[120:123], v12 offset:4608
    ds_read_b64_tr_b16 v[132:133], v13 offset:0
    ds_read_b64_tr_b16 v[134:135], v13 offset:1280
    ds_read_b64_tr_b16 v[136:137], v13 offset:64
    ds_read_b64_tr_b16 v[138:139], v13 offset:1344
    ds_read_b128 v[124:127], v12 offset:32
    ds_read_b128 v[128:131], v12 offset:4640
    ds_read_b64_tr_b16 v[140:141], v13 offset:5120
    ds_read_b64_tr_b16 v[142:143], v13 offset:6400
    ds_read_b64_tr_b16 v[144:145], v13 offset:5184
    ds_read_b64_tr_b16 v[146:147], v13 offset:6464
    s_waitcnt lgkmcnt(6)
    v_mfma_f32_32x32x16_bf16 v[148:163], v[116:119], v[132:135], v[148:163]
    v_mfma_f32_32x32x16_bf16 v[164:179], v[116:119], v[136:139], v[164:179]
    v_mfma_f32_32x32x16_bf16 v[180:195], v[120:123], v[132:135], v[180:195]
    v_mfma_f32_32x32x16_bf16 v[196:211], v[120:123], v[136:139], v[196:211]
    ds_read_b128 v[116:119], v12 offset:64
    ds_read_b128 v[120:123], v12 offset:4672
    ds_read_b64_tr_b16 v[132:133], v13 offset:10240
    ds_read_b64_tr_b16 v[134:135], v13 offset:11520
    ds_read_b64_tr_b16 v[136:137], v13 offset:10304
    ds_read_b64_tr_b16 v[138:139], v13 offset:11584
    s_waitcnt lgkmcnt(6)
    v_mfma_f32_32x32x16_bf16 v[148:163], v[124:127], v[140:143], v[148:163]
    v_mfma_f32_32x32x16_bf16 v[164:179], v[124:127], v[144:147], v[164:179]
    v_mfma_f32_32x32x16_bf16 v[180:195], v[128:131], v[140:143], v[180:195]
    v_mfma_f32_32x32x16_bf16 v[196:211], v[128:131], v[144:147], v[196:211]
    ds_read_b128 v[124:127], v12 offset:96
    ds_read_b128 v[128:131], v12 offset:4704
    ds_read_b64_tr_b16 v[140:141], v13 offset:15360
    ds_read_b64_tr_b16 v[142:143], v13 offset:16640
    ds_read_b64_tr_b16 v[144:145], v13 offset:15424
    ds_read_b64_tr_b16 v[146:147], v13 offset:16704
    s_waitcnt lgkmcnt(6)
    v_mfma_f32_32x32x16_bf16 v[148:163], v[116:119], v[132:135], v[148:163]
    v_mfma_f32_32x32x16_bf16 v[164:179], v[116:119], v[136:139], v[164:179]
    v_mfma_f32_32x32x16_bf16 v[180:195], v[120:123], v[132:135], v[180:195]
    v_mfma_f32_32x32x16_bf16 v[196:211], v[120:123], v[136:139], v[196:211]
    s_waitcnt lgkmcnt(0)
    v_mfma_f32_32x32x16_bf16 v[148:163], v[124:127], v[140:143], v[148:163]
    v_mfma_f32_32x32x16_bf16 v[164:179], v[124:127], v[144:147], v[164:179]
    v_mfma_f32_32x32x16_bf16 v[180:195], v[128:131], v[140:143], v[180:195]
    v_mfma_f32_32x32x16_bf16 v[196:211], v[128:131], v[144:147], v[196:211]
    s_waitcnt vmcnt(16)
    ds_write_b128 v10, v[20:23] offset:38912
    ds_write_b128 v10, v[24:27] offset:43520
    ds_write_b128 v10, v[28:31] offset:48128
    ds_write_b128 v10, v[32:35] offset:52736
    ds_write_b128 v11, v[36:39] offset:38912
    ds_write_b128 v11, v[40:43] offset:44032
    ds_write_b128 v11, v[44:47] offset:49152
    ds_write_b128 v11, v[48:51] offset:54272
    s_waitcnt lgkmcnt(0)
    s_barrier
    s_mov_b32 s31, 768
    s_mov_b32 s32, 1179648
    buffer_load_dwordx4 v[20:23], v2, s[12:15], s31 offen
    buffer_load_dwordx4 v[24:27], v3, s[12:15], s31 offen
    buffer_load_dwordx4 v[28:31], v4, s[12:15], s31 offen
    buffer_load_dwordx4 v[32:35], v5, s[12:15], s31 offen
    buffer_load_dwordx4 v[36:39], v6, s[16:19], s32 offen
    buffer_load_dwordx4 v[40:43], v7, s[16:19], s32 offen
    buffer_load_dwordx4 v[44:47], v8, s[16:19], s32 offen
    buffer_load_dwordx4 v[48:51], v9, s[16:19], s32 offen
    ds_read_b128 v[116:119], v12 offset:38912
    ds_read_b128 v[120:123], v12 offset:43520
    ds_read_b64_tr_b16 v[132:133], v13 offset:38912
    ds_read_b64_tr_b16 v[134:135], v13 offset:40192
    ds_read_b64_tr_b16 v[136:137], v13 offset:38976
    ds_read_b64_tr_b16 v[138:139], v13 offset:40256
    ds_read_b128 v[124:127], v12 offset:38944
    ds_read_b128 v[128:131], v12 offset:43552
    ds_read_b64_tr_b16 v[140:141], v13 offset:44032
    ds_read_b64_tr_b16 v[142:143], v13 offset:45312
    ds_read_b64_tr_b16 v[144:145], v13 offset:44096
    ds_read_b64_tr_b16 v[146:147], v13 offset:45376
    s_waitcnt lgkmcnt(6)
    v_mfma_f32_32x32x16_bf16 v[148:163], v[116:119], v[132:135], v[148:163]
    v_mfma_f32_32x32x16_bf16 v[164:179], v[116:119], v[136:139], v[164:179]
    v_mfma_f32_32x32x16_bf16 v[180:195], v[120:123], v[132:135], v[180:195]
    v_mfma_f32_32x32x16_bf16 v[196:211], v[120:123], v[136:139], v[196:211]
    ds_read_b128 v[116:119], v12 offset:38976
    ds_read_b128 v[120:123], v12 offset:43584
    ds_read_b64_tr_b16 v[132:133], v13 offset:49152
    ds_read_b64_tr_b16 v[134:135], v13 offset:50432
    ds_read_b64_tr_b16 v[136:137], v13 offset:49216
    ds_read_b64_tr_b16 v[138:139], v13 offset:50496
    s_waitcnt lgkmcnt(6)
    v_mfma_f32_32x32x16_bf16 v[148:163], v[124:127], v[140:143], v[148:163]
    v_mfma_f32_32x32x16_bf16 v[164:179], v[124:127], v[144:147], v[164:179]
    v_mfma_f32_32x32x16_bf16 v[180:195], v[128:131], v[140:143], v[180:195]
    v_mfma_f32_32x32x16_bf16 v[196:211], v[128:131], v[144:147], v[196:211]
    ds_read_b128 v[124:127], v12 offset:39008
    ds_read_b128 v[128:131], v12 offset:43616
    ds_read_b64_tr_b16 v[140:141], v13 offset:54272
    ds_read_b64_tr_b16 v[142:143], v13 offset:55552
    ds_read_b64_tr_b16 v[144:145], v13 offset:54336
    ds_read_b64_tr_b16 v[146:147], v13 offset:55616
    s_waitcnt lgkmcnt(6)
    v_mfma_f32_32x32x16_bf16 v[148:163], v[116:119], v[132:135], v[148:163]
    v_mfma_f32_32x32x16_bf16 v[164:179], v[116:119], v[136:139], v[164:179]
    v_mfma_f32_32x32x16_bf16 v[180:195], v[120:123], v[132:135], v[180:195]
    v_mfma_f32_32x32x16_bf16 v[196:211], v[120:123], v[136:139], v[196:211]
    s_waitcnt lgkmcnt(0)
    v_mfma_f32_32x32x16_bf16 v[148:163], v[124:127], v[140:143], v[148:163]
    v_mfma_f32_32x32x16_bf16 v[164:179], v[124:127], v[144:147], v[164:179]
    v_mfma_f32_32x32x16_bf16 v[180:195], v[128:131], v[140:143], v[180:195]
    v_mfma_f32_32x32x16_bf16 v[196:211], v[128:131], v[144:147], v[196:211]
    s_waitcnt vmcnt(16)
    ds_write_b128 v10, v[52:55] offset:0
    ds_write_b128 v10, v[56:59] offset:4608
    ds_write_b128 v10, v[60:63] offset:9216
    ds_write_b128 v10, v[64:67] offset:13824
    ds_write_b128 v11, v[68:71] offset:0
    ds_write_b128 v11, v[72:75] offset:5120
    ds_write_b128 v11, v[76:79] offset:10240
    ds_write_b128 v11, v[80:83] offset:15360
    s_waitcnt lgkmcnt(0)
    s_barrier
    s_mov_b32 s31, 896
    s_mov_b32 s32, 1376256
    buffer_load_dwordx4 v[52:55], v2, s[12:15], s31 offen
    buffer_load_dwordx4 v[56:59], v3, s[12:15], s31 offen
    buffer_load_dwordx4 v[60:63], v4, s[12:15], s31 offen
    buffer_load_dwordx4 v[64:67], v5, s[12:15], s31 offen
    buffer_load_dwordx4 v[68:71], v6, s[16:19], s32 offen
    buffer_load_dwordx4 v[72:75], v7, s[16:19], s32 offen
    buffer_load_dwordx4 v[76:79], v8, s[16:19], s32 offen
    buffer_load_dwordx4 v[80:83], v9, s[16:19], s32 offen
    ds_read_b128 v[116:119], v12 offset:0
    ds_read_b128 v[120:123], v12 offset:4608
    ds_read_b64_tr_b16 v[132:133], v13 offset:0
    ds_read_b64_tr_b16 v[134:135], v13 offset:1280
    ds_read_b64_tr_b16 v[136:137], v13 offset:64
    ds_read_b64_tr_b16 v[138:139], v13 offset:1344
    ds_read_b128 v[124:127], v12 offset:32
    ds_read_b128 v[128:131], v12 offset:4640
    ds_read_b64_tr_b16 v[140:141], v13 offset:5120
    ds_read_b64_tr_b16 v[142:143], v13 offset:6400
    ds_read_b64_tr_b16 v[144:145], v13 offset:5184
    ds_read_b64_tr_b16 v[146:147], v13 offset:6464
    s_waitcnt lgkmcnt(6)
    v_mfma_f32_32x32x16_bf16 v[148:163], v[116:119], v[132:135], v[148:163]
    v_mfma_f32_32x32x16_bf16 v[164:179], v[116:119], v[136:139], v[164:179]
    v_mfma_f32_32x32x16_bf16 v[180:195], v[120:123], v[132:135], v[180:195]
    v_mfma_f32_32x32x16_bf16 v[196:211], v[120:123], v[136:139], v[196:211]
    ds_read_b128 v[116:119], v12 offset:64
    ds_read_b128 v[120:123], v12 offset:4672
    ds_read_b64_tr_b16 v[132:133], v13 offset:10240
    ds_read_b64_tr_b16 v[134:135], v13 offset:11520
    ds_read_b64_tr_b16 v[136:137], v13 offset:10304
    ds_read_b64_tr_b16 v[138:139], v13 offset:11584
    s_waitcnt lgkmcnt(6)
    v_mfma_f32_32x32x16_bf16 v[148:163], v[124:127], v[140:143], v[148:163]
    v_mfma_f32_32x32x16_bf16 v[164:179], v[124:127], v[144:147], v[164:179]
    v_mfma_f32_32x32x16_bf16 v[180:195], v[128:131], v[140:143], v[180:195]
    v_mfma_f32_32x32x16_bf16 v[196:211], v[128:131], v[144:147], v[196:211]
    ds_read_b128 v[124:127], v12 offset:96
    ds_read_b128 v[128:131], v12 offset:4704
    ds_read_b64_tr_b16 v[140:141], v13 offset:15360
    ds_read_b64_tr_b16 v[142:143], v13 offset:16640
    ds_read_b64_tr_b16 v[144:145], v13 offset:15424
    ds_read_b64_tr_b16 v[146:147], v13 offset:16704
    s_waitcnt lgkmcnt(6)
    v_mfma_f32_32x32x16_bf16 v[148:163], v[116:119], v[132:135], v[148:163]
    v_mfma_f32_32x32x16_bf16 v[164:179], v[116:119], v[136:139], v[164:179]
    v_mfma_f32_32x32x16_bf16 v[180:195], v[120:123], v[132:135], v[180:195]
    v_mfma_f32_32x32x16_bf16 v[196:211], v[120:123], v[136:139], v[196:211]
    s_waitcnt lgkmcnt(0)
    v_mfma_f32_32x32x16_bf16 v[148:163], v[124:127], v[140:143], v[148:163]
    v_mfma_f32_32x32x16_bf16 v[164:179], v[124:127], v[144:147], v[164:179]
    v_mfma_f32_32x32x16_bf16 v[180:195], v[128:131], v[140:143], v[180:195]
    v_mfma_f32_32x32x16_bf16 v[196:211], v[128:131], v[144:147], v[196:211]
    s_waitcnt vmcnt(16)
    ds_write_b128 v10, v[84:87] offset:38912
    ds_write_b128 v10, v[88:91] offset:43520
    ds_write_b128 v10, v[92:95] offset:48128
    ds_write_b128 v10, v[96:99] offset:52736
    ds_write_b128 v11, v[100:103] offset:38912
    ds_write_b128 v11, v[104:107] offset:44032
    ds_write_b128 v11, v[108:111] offset:49152
    ds_write_b128 v11, v[112:115] offset:54272
    s_waitcnt lgkmcnt(0)
    s_barrier
    ds_read_b128 v[116:119], v12 offset:38912
    ds_read_b128 v[120:123], v12 offset:43520
    ds_read_b64_tr_b16 v[132:133], v13 offset:38912
    ds_read_b64_tr_b16 v[134:135], v13 offset:40192
    ds_read_b64_tr_b16 v[136:137], v13 offset:38976
    ds_read_b64_tr_b16 v[138:139], v13 offset:40256
    ds_read_b128 v[124:127], v12 offset:38944
    ds_read_b128 v[128:131], v12 offset:43552
    ds_read_b64_tr_b16 v[140:141], v13 offset:44032
    ds_read_b64_tr_b16 v[142:143], v13 offset:45312
    ds_read_b64_tr_b16 v[144:145], v13 offset:44096
    ds_read_b64_tr_b16 v[146:147], v13 offset:45376
    s_waitcnt lgkmcnt(6)
    v_mfma_f32_32x32x16_bf16 v[148:163], v[116:119], v[132:135], v[148:163]
    v_mfma_f32_32x32x16_bf16 v[164:179], v[116:119], v[136:139], v[164:179]
    v_mfma_f32_32x32x16_bf16 v[180:195], v[120:123], v[132:135], v[180:195]
    v_mfma_f32_32x32x16_bf16 v[196:211], v[120:123], v[136:139], v[196:211]
    ds_read_b128 v[116:119], v12 offset:38976
    ds_read_b128 v[120:123], v12 offset:43584
    ds_read_b64_tr_b16 v[132:133], v13 offset:49152
    ds_read_b64_tr_b16 v[134:135], v13 offset:50432
    ds_read_b64_tr_b16 v[136:137], v13 offset:49216
    ds_read_b64_tr_b16 v[138:139], v13 offset:50496
    s_waitcnt lgkmcnt(6)
    v_mfma_f32_32x32x16_bf16 v[148:163], v[124:127], v[140:143], v[148:163]
    v_mfma_f32_32x32x16_bf16 v[164:179], v[124:127], v[144:147], v[164:179]
    v_mfma_f32_32x32x16_bf16 v[180:195], v[128:131], v[140:143], v[180:195]
    v_mfma_f32_32x32x16_bf16 v[196:211], v[128:131], v[144:147], v[196:211]
    ds_read_b128 v[124:127], v12 offset:39008
    ds_read_b128 v[128:131], v12 offset:43616
    ds_read_b64_tr_b16 v[140:141], v13 offset:54272
    ds_read_b64_tr_b16 v[142:143], v13 offset:55552
    ds_read_b64_tr_b16 v[144:145], v13 offset:54336
    ds_read_b64_tr_b16 v[146:147], v13 offset:55616
    s_waitcnt lgkmcnt(6)
    v_mfma_f32_32x32x16_bf16 v[148:163], v[116:119], v[132:135], v[148:163]
    v_mfma_f32_32x32x16_bf16 v[164:179], v[116:119], v[136:139], v[164:179]
    v_mfma_f32_32x32x16_bf16 v[180:195], v[120:123], v[132:135], v[180:195]
    v_mfma_f32_32x32x16_bf16 v[196:211], v[120:123], v[136:139], v[196:211]
    s_waitcnt lgkmcnt(0)
    v_mfma_f32_32x32x16_bf16 v[148:163], v[124:127], v[140:143], v[148:163]
    v_mfma_f32_32x32x16_bf16 v[164:179], v[124:127], v[144:147], v[164:179]
    v_mfma_f32_32x32x16_bf16 v[180:195], v[128:131], v[140:143], v[180:195]
    v_mfma_f32_32x32x16_bf16 v[196:211], v[128:131], v[144:147], v[196:211]
    s_waitcnt vmcnt(8)
    ds_write_b128 v10, v[20:23] offset:0
    ds_write_b128 v10, v[24:27] offset:4608
    ds_write_b128 v10, v[28:31] offset:9216
    ds_write_b128 v10, v[32:35] offset:13824
    ds_write_b128 v11, v[36:39] offset:0
    ds_write_b128 v11, v[40:43] offset:5120
    ds_write_b128 v11, v[44:47] offset:10240
    ds_write_b128 v11, v[48:51] offset:15360
    s_waitcnt lgkmcnt(0)
    s_barrier
    ds_read_b128 v[116:119], v12 offset:0
    ds_read_b128 v[120:123], v12 offset:4608
    ds_read_b64_tr_b16 v[132:133], v13 offset:0
    ds_read_b64_tr_b16 v[134:135], v13 offset:1280
    ds_read_b64_tr_b16 v[136:137], v13 offset:64
    ds_read_b64_tr_b16 v[138:139], v13 offset:1344
    ds_read_b128 v[124:127], v12 offset:32
    ds_read_b128 v[128:131], v12 offset:4640
    ds_read_b64_tr_b16 v[140:141], v13 offset:5120
    ds_read_b64_tr_b16 v[142:143], v13 offset:6400
    ds_read_b64_tr_b16 v[144:145], v13 offset:5184
    ds_read_b64_tr_b16 v[146:147], v13 offset:6464
    s_waitcnt lgkmcnt(6)
    v_mfma_f32_32x32x16_bf16 v[148:163], v[116:119], v[132:135], v[148:163]
    v_mfma_f32_32x32x16_bf16 v[164:179], v[116:119], v[136:139], v[164:179]
    v_mfma_f32_32x32x16_bf16 v[180:195], v[120:123], v[132:135], v[180:195]
    v_mfma_f32_32x32x16_bf16 v[196:211], v[120:123], v[136:139], v[196:211]
    ds_read_b128 v[116:119], v12 offset:64
    ds_read_b128 v[120:123], v12 offset:4672
    ds_read_b64_tr_b16 v[132:133], v13 offset:10240
    ds_read_b64_tr_b16 v[134:135], v13 offset:11520
    ds_read_b64_tr_b16 v[136:137], v13 offset:10304
    ds_read_b64_tr_b16 v[138:139], v13 offset:11584
    s_waitcnt lgkmcnt(6)
    v_mfma_f32_32x32x16_bf16 v[148:163], v[124:127], v[140:143], v[148:163]
    v_mfma_f32_32x32x16_bf16 v[164:179], v[124:127], v[144:147], v[164:179]
    v_mfma_f32_32x32x16_bf16 v[180:195], v[128:131], v[140:143], v[180:195]
    v_mfma_f32_32x32x16_bf16 v[196:211], v[128:131], v[144:147], v[196:211]
    ds_read_b128 v[124:127], v12 offset:96
    ds_read_b128 v[128:131], v12 offset:4704
    ds_read_b64_tr_b16 v[140:141], v13 offset:15360
    ds_read_b64_tr_b16 v[142:143], v13 offset:16640
    ds_read_b64_tr_b16 v[144:145], v13 offset:15424
    ds_read_b64_tr_b16 v[146:147], v13 offset:16704
    s_waitcnt lgkmcnt(6)
    v_mfma_f32_32x32x16_bf16 v[148:163], v[116:119], v[132:135], v[148:163]
    v_mfma_f32_32x32x16_bf16 v[164:179], v[116:119], v[136:139], v[164:179]
    v_mfma_f32_32x32x16_bf16 v[180:195], v[120:123], v[132:135], v[180:195]
    v_mfma_f32_32x32x16_bf16 v[196:211], v[120:123], v[136:139], v[196:211]
    s_waitcnt lgkmcnt(0)
    v_mfma_f32_32x32x16_bf16 v[148:163], v[124:127], v[140:143], v[148:163]
    v_mfma_f32_32x32x16_bf16 v[164:179], v[124:127], v[144:147], v[164:179]
    v_mfma_f32_32x32x16_bf16 v[180:195], v[128:131], v[140:143], v[180:195]
    v_mfma_f32_32x32x16_bf16 v[196:211], v[128:131], v[144:147], v[196:211]
    s_waitcnt vmcnt(0)
    ds_write_b128 v10, v[52:55] offset:38912
    ds_write_b128 v10, v[56:59] offset:43520
    ds_write_b128 v10, v[60:63] offset:48128
    ds_write_b128 v10, v[64:67] offset:52736
    ds_write_b128 v11, v[68:71] offset:38912
    ds_write_b128 v11, v[72:75] offset:44032
    ds_write_b128 v11, v[76:79] offset:49152
    ds_write_b128 v11, v[80:83] offset:54272
    s_waitcnt lgkmcnt(0)
    s_barrier
    ds_read_b128 v[116:119], v12 offset:38912
    ds_read_b128 v[120:123], v12 offset:43520
    ds_read_b64_tr_b16 v[132:133], v13 offset:38912
    ds_read_b64_tr_b16 v[134:135], v13 offset:40192
    ds_read_b64_tr_b16 v[136:137], v13 offset:38976
    ds_read_b64_tr_b16 v[138:139], v13 offset:40256
    ds_read_b128 v[124:127], v12 offset:38944
    ds_read_b128 v[128:131], v12 offset:43552
    ds_read_b64_tr_b16 v[140:141], v13 offset:44032
    ds_read_b64_tr_b16 v[142:143], v13 offset:45312
    ds_read_b64_tr_b16 v[144:145], v13 offset:44096
    ds_read_b64_tr_b16 v[146:147], v13 offset:45376
    s_waitcnt lgkmcnt(6)
    v_mfma_f32_32x32x16_bf16 v[148:163], v[116:119], v[132:135], v[148:163]
    v_mfma_f32_32x32x16_bf16 v[164:179], v[116:119], v[136:139], v[164:179]
    v_mfma_f32_32x32x16_bf16 v[180:195], v[120:123], v[132:135], v[180:195]
    v_mfma_f32_32x32x16_bf16 v[196:211], v[120:123], v[136:139], v[196:211]
    ds_read_b128 v[116:119], v12 offset:38976
    ds_read_b128 v[120:123], v12 offset:43584
    ds_read_b64_tr_b16 v[132:133], v13 offset:49152
    ds_read_b64_tr_b16 v[134:135], v13 offset:50432
    ds_read_b64_tr_b16 v[136:137], v13 offset:49216
    ds_read_b64_tr_b16 v[138:139], v13 offset:50496
    s_waitcnt lgkmcnt(6)
    v_mfma_f32_32x32x16_bf16 v[148:163], v[124:127], v[140:143], v[148:163]
    v_mfma_f32_32x32x16_bf16 v[164:179], v[124:127], v[144:147], v[164:179]
    v_mfma_f32_32x32x16_bf16 v[180:195], v[128:131], v[140:143], v[180:195]
    v_mfma_f32_32x32x16_bf16 v[196:211], v[128:131], v[144:147], v[196:211]
    ds_read_b128 v[124:127], v12 offset:39008
    ds_read_b128 v[128:131], v12 offset:43616
    ds_read_b64_tr_b16 v[140:141], v13 offset:54272
    ds_read_b64_tr_b16 v[142:143], v13 offset:55552
    ds_read_b64_tr_b16 v[144:145], v13 offset:54336
    ds_read_b64_tr_b16 v[146:147], v13 offset:55616
    s_waitcnt lgkmcnt(6)
    v_mfma_f32_32x32x16_bf16 v[148:163], v[116:119], v[132:135], v[148:163]
    v_mfma_f32_32x32x16_bf16 v[164:179], v[116:119], v[136:139], v[164:179]
    v_mfma_f32_32x32x16_bf16 v[180:195], v[120:123], v[132:135], v[180:195]
    v_mfma_f32_32x32x16_bf16 v[196:211], v[120:123], v[136:139], v[196:211]
    s_waitcnt lgkmcnt(0)
    v_mfma_f32_32x32x16_bf16 v[148:163], v[124:127], v[140:143], v[148:163]
    v_mfma_f32_32x32x16_bf16 v[164:179], v[124:127], v[144:147], v[164:179]
    v_mfma_f32_32x32x16_bf16 v[180:195], v[128:131], v[140:143], v[180:195]
    v_mfma_f32_32x32x16_bf16 v[196:211], v[128:131], v[144:147], v[196:211]
    s_nop 15
    s_nop 3
    v_and_b32 v14, 31, v1
    v_lshlrev_b32 v14, 12, v14
    v_lshrrev_b32 v15, 5, v1
    v_lshl_add_u32 v14, v15, 3, v14
    s_sub_u32 s29, s25, 8
    s_lshl_b32 s29, s29, 7
    s_lshl_b32 s30, s27, 6
    s_add_u32 s29, s29, s30
    s_lshl_b32 s29, s29, 12
    s_lshl_b32 s30, s24, 8
    s_lshl_b32 s31, s28, 7
    s_add_u32 s30, s30, s31
    s_add_u32 s29, s29, s30
    s_add_u32 s29, s29, 4194304

    s_add_u32 s33, s29, 0
    v_cvt_pk_bf16_f32 v20, v148, v149
    v_cvt_pk_bf16_f32 v21, v150, v151
    buffer_store_dwordx2 v[20:21], v14, s[20:23], s33 offen offset:0
    s_nop 1
    v_cvt_pk_bf16_f32 v22, v152, v153
    v_cvt_pk_bf16_f32 v23, v154, v155
    buffer_store_dwordx2 v[22:23], v14, s[20:23], s33 offen offset:16
    s_nop 1
    v_cvt_pk_bf16_f32 v20, v156, v157
    v_cvt_pk_bf16_f32 v21, v158, v159
    buffer_store_dwordx2 v[20:21], v14, s[20:23], s33 offen offset:32
    s_nop 1
    v_cvt_pk_bf16_f32 v22, v160, v161
    v_cvt_pk_bf16_f32 v23, v162, v163
    buffer_store_dwordx2 v[22:23], v14, s[20:23], s33 offen offset:48
    s_nop 1
    s_add_u32 s33, s29, 131072
    v_cvt_pk_bf16_f32 v20, v164, v165
    v_cvt_pk_bf16_f32 v21, v166, v167
    buffer_store_dwordx2 v[20:21], v14, s[20:23], s33 offen offset:0
    s_nop 1
    v_cvt_pk_bf16_f32 v22, v168, v169
    v_cvt_pk_bf16_f32 v23, v170, v171
    buffer_store_dwordx2 v[22:23], v14, s[20:23], s33 offen offset:16
    s_nop 1
    v_cvt_pk_bf16_f32 v20, v172, v173
    v_cvt_pk_bf16_f32 v21, v174, v175
    buffer_store_dwordx2 v[20:21], v14, s[20:23], s33 offen offset:32
    s_nop 1
    v_cvt_pk_bf16_f32 v22, v176, v177
    v_cvt_pk_bf16_f32 v23, v178, v179
    buffer_store_dwordx2 v[22:23], v14, s[20:23], s33 offen offset:48
    s_nop 1
    s_add_u32 s33, s29, 64
    v_cvt_pk_bf16_f32 v20, v180, v181
    v_cvt_pk_bf16_f32 v21, v182, v183
    buffer_store_dwordx2 v[20:21], v14, s[20:23], s33 offen offset:0
    s_nop 1
    v_cvt_pk_bf16_f32 v22, v184, v185
    v_cvt_pk_bf16_f32 v23, v186, v187
    buffer_store_dwordx2 v[22:23], v14, s[20:23], s33 offen offset:16
    s_nop 1
    v_cvt_pk_bf16_f32 v20, v188, v189
    v_cvt_pk_bf16_f32 v21, v190, v191
    buffer_store_dwordx2 v[20:21], v14, s[20:23], s33 offen offset:32
    s_nop 1
    v_cvt_pk_bf16_f32 v22, v192, v193
    v_cvt_pk_bf16_f32 v23, v194, v195
    buffer_store_dwordx2 v[22:23], v14, s[20:23], s33 offen offset:48
    s_nop 1
    s_add_u32 s33, s29, 131136
    v_cvt_pk_bf16_f32 v20, v196, v197
    v_cvt_pk_bf16_f32 v21, v198, v199
    buffer_store_dwordx2 v[20:21], v14, s[20:23], s33 offen offset:0
    s_nop 1
    v_cvt_pk_bf16_f32 v22, v200, v201
    v_cvt_pk_bf16_f32 v23, v202, v203
    buffer_store_dwordx2 v[22:23], v14, s[20:23], s33 offen offset:16
    s_nop 1
    v_cvt_pk_bf16_f32 v20, v204, v205
    v_cvt_pk_bf16_f32 v21, v206, v207
    buffer_store_dwordx2 v[20:21], v14, s[20:23], s33 offen offset:32
    s_nop 1
    v_cvt_pk_bf16_f32 v22, v208, v209
    v_cvt_pk_bf16_f32 v23, v210, v211
    buffer_store_dwordx2 v[22:23], v14, s[20:23], s33 offen offset:48
    s_nop 1
Le_3:
    s_endpgm
Lnext_1:
    s_sub_u32 s2, s2, 192
    s_cmp_ge_u32 s2, 64
    s_cbranch_scc1 Lnext_4
    s_load_dwordx2 s[4:5], s[0:1], 8
    s_load_dwordx2 s[6:7], s[0:1], 16
    s_load_dwordx2 s[8:9], s[0:1], 24
    s_load_dwordx2 s[10:11], s[0:1], 96
    v_and_b32 v1, 63, v0
    v_lshrrev_b32 v2, 6, v0
    s_nop 0
    v_readfirstlane_b32 s26, v2
    s_waitcnt lgkmcnt(0)
    s_mov_b32 s12, s4
    s_mov_b32 s13, s5
    s_mov_b32 s14, 2097152
    s_mov_b32 s15, 0x00020000
    s_mov_b32 s16, s6
    s_mov_b32 s17, s7
    s_mov_b32 s18, 2097152
    s_mov_b32 s19, 0x00020000
    s_mov_b32 s20, s8
    s_mov_b32 s21, s9
    s_mov_b32 s22, 4096
    s_mov_b32 s23, 0x00020000
    s_mov_b32 s28, s10
    s_mov_b32 s29, s11
    s_mov_b32 s30, 16777216
    s_mov_b32 s31, 0x00020000
    s_lshl_b32 s27, s2, 2
    s_add_u32 s27, s27, s26
    s_lshr_b32 s32, s27, 2
    s_and_b32 s33, s27, 3
    s_lshl_b32 s34, s32, 15
    s_lshl_b32 s35, s33, 8
    s_add_u32 s34, s34, s35
    v_lshlrev_b32 v2, 2, v1
    v_add_u32 v3, s34, v2
    v_subrev_u32 v4, 3072, v3
    v_lshl_add_u32 v5, s33, 6, v1
    v_lshlrev_b32 v5, 4, v5
    buffer_load_dwordx4 v[76:79], v5, s[20:23], 0 offen

    buffer_load_dword v8, v4, s[12:15], 0 offen offset:0
    buffer_load_dword v9, v4, s[12:15], 0 offen offset:1024
    buffer_load_dword v10, v4, s[12:15], 0 offen offset:2048
    s_mov_b32 s36, 0
    buffer_load_dword v11, v3, s[12:15], s36 offen offset:0
    buffer_load_dword v44, v3, s[16:19], s36 offen offset:0
    s_mov_b32 s36, 0
    buffer_load_dword v12, v3, s[12:15], s36 offen offset:1024
    buffer_load_dword v45, v3, s[16:19], s36 offen offset:1024
    s_mov_b32 s36, 0
    buffer_load_dword v13, v3, s[12:15], s36 offen offset:2048
    buffer_load_dword v46, v3, s[16:19], s36 offen offset:2048
    s_mov_b32 s36, 0
    buffer_load_dword v14, v3, s[12:15], s36 offen offset:3072
    buffer_load_dword v47, v3, s[16:19], s36 offen offset:3072
    s_mov_b32 s36, 4096
    buffer_load_dword v15, v3, s[12:15], s36 offen offset:0
    buffer_load_dword v48, v3, s[16:19], s36 offen offset:0
    s_mov_b32 s36, 4096
    buffer_load_dword v16, v3, s[12:15], s36 offen offset:1024
    buffer_load_dword v49, v3, s[16:19], s36 offen offset:1024
    s_mov_b32 s36, 4096
    buffer_load_dword v17, v3, s[12:15], s36 offen offset:2048
    buffer_load_dword v50, v3, s[16:19], s36 offen offset:2048
    s_mov_b32 s36, 4096
    buffer_load_dword v18, v3, s[12:15], s36 offen offset:3072
    buffer_load_dword v51, v3, s[16:19], s36 offen offset:3072
    s_mov_b32 s36, 8192
    buffer_load_dword v19, v3, s[12:15], s36 offen offset:0
    buffer_load_dword v52, v3, s[16:19], s36 offen offset:0
    s_mov_b32 s36, 8192
    buffer_load_dword v20, v3, s[12:15], s36 offen offset:1024
    buffer_load_dword v53, v3, s[16:19], s36 offen offset:1024
    s_mov_b32 s36, 8192
    buffer_load_dword v21, v3, s[12:15], s36 offen offset:2048
    buffer_load_dword v54, v3, s[16:19], s36 offen offset:2048
    s_mov_b32 s36, 8192
    buffer_load_dword v22, v3, s[12:15], s36 offen offset:3072
    buffer_load_dword v55, v3, s[16:19], s36 offen offset:3072
    s_mov_b32 s36, 12288
    buffer_load_dword v23, v3, s[12:15], s36 offen offset:0
    buffer_load_dword v56, v3, s[16:19], s36 offen offset:0
    s_mov_b32 s36, 12288
    buffer_load_dword v24, v3, s[12:15], s36 offen offset:1024
    buffer_load_dword v57, v3, s[16:19], s36 offen offset:1024
    s_mov_b32 s36, 12288
    buffer_load_dword v25, v3, s[12:15], s36 offen offset:2048
    buffer_load_dword v58, v3, s[16:19], s36 offen offset:2048
    s_mov_b32 s36, 12288
    buffer_load_dword v26, v3, s[12:15], s36 offen offset:3072
    buffer_load_dword v59, v3, s[16:19], s36 offen offset:3072
    s_mov_b32 s36, 16384
    buffer_load_dword v27, v3, s[12:15], s36 offen offset:0
    buffer_load_dword v60, v3, s[16:19], s36 offen offset:0
    s_mov_b32 s36, 16384
    buffer_load_dword v28, v3, s[12:15], s36 offen offset:1024
    buffer_load_dword v61, v3, s[16:19], s36 offen offset:1024
    s_mov_b32 s36, 16384
    buffer_load_dword v29, v3, s[12:15], s36 offen offset:2048
    buffer_load_dword v62, v3, s[16:19], s36 offen offset:2048
    s_mov_b32 s36, 16384
    buffer_load_dword v30, v3, s[12:15], s36 offen offset:3072
    buffer_load_dword v63, v3, s[16:19], s36 offen offset:3072
    s_mov_b32 s36, 20480
    buffer_load_dword v31, v3, s[12:15], s36 offen offset:0
    buffer_load_dword v64, v3, s[16:19], s36 offen offset:0
    s_mov_b32 s36, 20480
    buffer_load_dword v32, v3, s[12:15], s36 offen offset:1024
    buffer_load_dword v65, v3, s[16:19], s36 offen offset:1024
    s_mov_b32 s36, 20480
    buffer_load_dword v33, v3, s[12:15], s36 offen offset:2048
    buffer_load_dword v66, v3, s[16:19], s36 offen offset:2048
    s_mov_b32 s36, 20480
    buffer_load_dword v34, v3, s[12:15], s36 offen offset:3072
    buffer_load_dword v67, v3, s[16:19], s36 offen offset:3072
    s_mov_b32 s36, 24576
    buffer_load_dword v35, v3, s[12:15], s36 offen offset:0
    buffer_load_dword v68, v3, s[16:19], s36 offen offset:0
    s_mov_b32 s36, 24576
    buffer_load_dword v36, v3, s[12:15], s36 offen offset:1024
    buffer_load_dword v69, v3, s[16:19], s36 offen offset:1024
    s_mov_b32 s36, 24576
    buffer_load_dword v37, v3, s[12:15], s36 offen offset:2048
    buffer_load_dword v70, v3, s[16:19], s36 offen offset:2048
    s_mov_b32 s36, 24576
    buffer_load_dword v38, v3, s[12:15], s36 offen offset:3072
    buffer_load_dword v71, v3, s[16:19], s36 offen offset:3072
    s_mov_b32 s36, 28672
    buffer_load_dword v39, v3, s[12:15], s36 offen offset:0
    buffer_load_dword v72, v3, s[16:19], s36 offen offset:0
    s_mov_b32 s36, 28672
    buffer_load_dword v40, v3, s[12:15], s36 offen offset:1024
    buffer_load_dword v73, v3, s[16:19], s36 offen offset:1024
    s_mov_b32 s36, 28672
    buffer_load_dword v41, v3, s[12:15], s36 offen offset:2048
    buffer_load_dword v74, v3, s[16:19], s36 offen offset:2048
    s_mov_b32 s36, 28672
    buffer_load_dword v42, v3, s[12:15], s36 offen offset:3072
    buffer_load_dword v75, v3, s[16:19], s36 offen offset:3072
    s_waitcnt vmcnt(0)
    v_lshlrev_b32 v112, 16, v76
    v_and_b32 v113, 0xffff0000, v76
    v_lshlrev_b32 v114, 16, v77
    v_and_b32 v115, 0xffff0000, v77

    v_lshlrev_b32 v116, 16, v78
    v_and_b32 v117, 0xffff0000, v78
    v_lshlrev_b32 v118, 16, v79
    v_and_b32 v119, 0xffff0000, v79

    v_lshlrev_b32 v120, 16, v8
    v_lshlrev_b32 v121, 16, v9
    v_lshlrev_b32 v122, 16, v10
    v_lshlrev_b32 v123, 16, v11
    v_mul_f32 v124, v115, v120
    v_fmac_f32 v124, v114, v121
    v_fmac_f32 v124, v113, v122
    v_fmac_f32 v124, v112, v123

    v_lshlrev_b32 v120, 16, v12
    v_mul_f32 v125, v115, v121
    v_fmac_f32 v125, v114, v122
    v_fmac_f32 v125, v113, v123
    v_fmac_f32 v125, v112, v120

    v_cvt_pk_bf16_f32 v126, v124, v125
    v_lshlrev_b32 v124, 16, v126
    v_and_b32 v125, 0xffff0000, v126

    v_lshlrev_b32 v126, 16, v44
    v_lshlrev_b32 v127, 16, v45
    v_mul_f32 v124, v124, v126
    v_mul_f32 v125, v125, v127
    v_cvt_pk_bf16_f32 v80, v124, v125

    v_lshlrev_b32 v121, 16, v13
    v_mul_f32 v124, v115, v122
    v_fmac_f32 v124, v114, v123
    v_fmac_f32 v124, v113, v120
    v_fmac_f32 v124, v112, v121

    v_lshlrev_b32 v122, 16, v14
    v_mul_f32 v125, v115, v123
    v_fmac_f32 v125, v114, v120
    v_fmac_f32 v125, v113, v121
    v_fmac_f32 v125, v112, v122

    v_cvt_pk_bf16_f32 v126, v124, v125
    v_lshlrev_b32 v124, 16, v126
    v_and_b32 v125, 0xffff0000, v126

    v_lshlrev_b32 v126, 16, v46
    v_lshlrev_b32 v127, 16, v47
    v_mul_f32 v124, v124, v126
    v_mul_f32 v125, v125, v127
    v_cvt_pk_bf16_f32 v81, v124, v125

    v_lshlrev_b32 v123, 16, v15
    v_mul_f32 v124, v115, v120
    v_fmac_f32 v124, v114, v121
    v_fmac_f32 v124, v113, v122
    v_fmac_f32 v124, v112, v123

    v_lshlrev_b32 v120, 16, v16
    v_mul_f32 v125, v115, v121
    v_fmac_f32 v125, v114, v122
    v_fmac_f32 v125, v113, v123
    v_fmac_f32 v125, v112, v120

    v_cvt_pk_bf16_f32 v126, v124, v125
    v_lshlrev_b32 v124, 16, v126
    v_and_b32 v125, 0xffff0000, v126

    v_lshlrev_b32 v126, 16, v48
    v_lshlrev_b32 v127, 16, v49
    v_mul_f32 v124, v124, v126
    v_mul_f32 v125, v125, v127
    v_cvt_pk_bf16_f32 v82, v124, v125

    v_lshlrev_b32 v121, 16, v17
    v_mul_f32 v124, v115, v122
    v_fmac_f32 v124, v114, v123
    v_fmac_f32 v124, v113, v120
    v_fmac_f32 v124, v112, v121

    v_lshlrev_b32 v122, 16, v18
    v_mul_f32 v125, v115, v123
    v_fmac_f32 v125, v114, v120
    v_fmac_f32 v125, v113, v121
    v_fmac_f32 v125, v112, v122

    v_cvt_pk_bf16_f32 v126, v124, v125
    v_lshlrev_b32 v124, 16, v126
    v_and_b32 v125, 0xffff0000, v126

    v_lshlrev_b32 v126, 16, v50
    v_lshlrev_b32 v127, 16, v51
    v_mul_f32 v124, v124, v126
    v_mul_f32 v125, v125, v127
    v_cvt_pk_bf16_f32 v83, v124, v125

    v_lshlrev_b32 v123, 16, v19
    v_mul_f32 v124, v115, v120
    v_fmac_f32 v124, v114, v121
    v_fmac_f32 v124, v113, v122
    v_fmac_f32 v124, v112, v123

    v_lshlrev_b32 v120, 16, v20
    v_mul_f32 v125, v115, v121
    v_fmac_f32 v125, v114, v122
    v_fmac_f32 v125, v113, v123
    v_fmac_f32 v125, v112, v120

    v_cvt_pk_bf16_f32 v126, v124, v125
    v_lshlrev_b32 v124, 16, v126
    v_and_b32 v125, 0xffff0000, v126

    v_lshlrev_b32 v126, 16, v52
    v_lshlrev_b32 v127, 16, v53
    v_mul_f32 v124, v124, v126
    v_mul_f32 v125, v125, v127
    v_cvt_pk_bf16_f32 v84, v124, v125

    v_lshlrev_b32 v121, 16, v21
    v_mul_f32 v124, v115, v122
    v_fmac_f32 v124, v114, v123
    v_fmac_f32 v124, v113, v120
    v_fmac_f32 v124, v112, v121

    v_lshlrev_b32 v122, 16, v22
    v_mul_f32 v125, v115, v123
    v_fmac_f32 v125, v114, v120
    v_fmac_f32 v125, v113, v121
    v_fmac_f32 v125, v112, v122

    v_cvt_pk_bf16_f32 v126, v124, v125
    v_lshlrev_b32 v124, 16, v126
    v_and_b32 v125, 0xffff0000, v126

    v_lshlrev_b32 v126, 16, v54
    v_lshlrev_b32 v127, 16, v55
    v_mul_f32 v124, v124, v126
    v_mul_f32 v125, v125, v127
    v_cvt_pk_bf16_f32 v85, v124, v125

    v_lshlrev_b32 v123, 16, v23
    v_mul_f32 v124, v115, v120
    v_fmac_f32 v124, v114, v121
    v_fmac_f32 v124, v113, v122
    v_fmac_f32 v124, v112, v123

    v_lshlrev_b32 v120, 16, v24
    v_mul_f32 v125, v115, v121
    v_fmac_f32 v125, v114, v122
    v_fmac_f32 v125, v113, v123
    v_fmac_f32 v125, v112, v120

    v_cvt_pk_bf16_f32 v126, v124, v125
    v_lshlrev_b32 v124, 16, v126
    v_and_b32 v125, 0xffff0000, v126

    v_lshlrev_b32 v126, 16, v56
    v_lshlrev_b32 v127, 16, v57
    v_mul_f32 v124, v124, v126
    v_mul_f32 v125, v125, v127
    v_cvt_pk_bf16_f32 v86, v124, v125

    v_lshlrev_b32 v121, 16, v25
    v_mul_f32 v124, v115, v122
    v_fmac_f32 v124, v114, v123
    v_fmac_f32 v124, v113, v120
    v_fmac_f32 v124, v112, v121

    v_lshlrev_b32 v122, 16, v26
    v_mul_f32 v125, v115, v123
    v_fmac_f32 v125, v114, v120
    v_fmac_f32 v125, v113, v121
    v_fmac_f32 v125, v112, v122

    v_cvt_pk_bf16_f32 v126, v124, v125
    v_lshlrev_b32 v124, 16, v126
    v_and_b32 v125, 0xffff0000, v126

    v_lshlrev_b32 v126, 16, v58
    v_lshlrev_b32 v127, 16, v59
    v_mul_f32 v124, v124, v126
    v_mul_f32 v125, v125, v127
    v_cvt_pk_bf16_f32 v87, v124, v125

    v_lshlrev_b32 v123, 16, v27
    v_mul_f32 v124, v115, v120
    v_fmac_f32 v124, v114, v121
    v_fmac_f32 v124, v113, v122
    v_fmac_f32 v124, v112, v123

    v_lshlrev_b32 v120, 16, v28
    v_mul_f32 v125, v115, v121
    v_fmac_f32 v125, v114, v122
    v_fmac_f32 v125, v113, v123
    v_fmac_f32 v125, v112, v120

    v_cvt_pk_bf16_f32 v126, v124, v125
    v_lshlrev_b32 v124, 16, v126
    v_and_b32 v125, 0xffff0000, v126

    v_lshlrev_b32 v126, 16, v60
    v_lshlrev_b32 v127, 16, v61
    v_mul_f32 v124, v124, v126
    v_mul_f32 v125, v125, v127
    v_cvt_pk_bf16_f32 v88, v124, v125

    v_lshlrev_b32 v121, 16, v29
    v_mul_f32 v124, v115, v122
    v_fmac_f32 v124, v114, v123
    v_fmac_f32 v124, v113, v120
    v_fmac_f32 v124, v112, v121

    v_lshlrev_b32 v122, 16, v30
    v_mul_f32 v125, v115, v123
    v_fmac_f32 v125, v114, v120
    v_fmac_f32 v125, v113, v121
    v_fmac_f32 v125, v112, v122

    v_cvt_pk_bf16_f32 v126, v124, v125
    v_lshlrev_b32 v124, 16, v126
    v_and_b32 v125, 0xffff0000, v126

    v_lshlrev_b32 v126, 16, v62
    v_lshlrev_b32 v127, 16, v63
    v_mul_f32 v124, v124, v126
    v_mul_f32 v125, v125, v127
    v_cvt_pk_bf16_f32 v89, v124, v125

    v_lshlrev_b32 v123, 16, v31
    v_mul_f32 v124, v115, v120
    v_fmac_f32 v124, v114, v121
    v_fmac_f32 v124, v113, v122
    v_fmac_f32 v124, v112, v123

    v_lshlrev_b32 v120, 16, v32
    v_mul_f32 v125, v115, v121
    v_fmac_f32 v125, v114, v122
    v_fmac_f32 v125, v113, v123
    v_fmac_f32 v125, v112, v120

    v_cvt_pk_bf16_f32 v126, v124, v125
    v_lshlrev_b32 v124, 16, v126
    v_and_b32 v125, 0xffff0000, v126

    v_lshlrev_b32 v126, 16, v64
    v_lshlrev_b32 v127, 16, v65
    v_mul_f32 v124, v124, v126
    v_mul_f32 v125, v125, v127
    v_cvt_pk_bf16_f32 v90, v124, v125

    v_lshlrev_b32 v121, 16, v33
    v_mul_f32 v124, v115, v122
    v_fmac_f32 v124, v114, v123
    v_fmac_f32 v124, v113, v120
    v_fmac_f32 v124, v112, v121

    v_lshlrev_b32 v122, 16, v34
    v_mul_f32 v125, v115, v123
    v_fmac_f32 v125, v114, v120
    v_fmac_f32 v125, v113, v121
    v_fmac_f32 v125, v112, v122

    v_cvt_pk_bf16_f32 v126, v124, v125
    v_lshlrev_b32 v124, 16, v126
    v_and_b32 v125, 0xffff0000, v126

    v_lshlrev_b32 v126, 16, v66
    v_lshlrev_b32 v127, 16, v67
    v_mul_f32 v124, v124, v126
    v_mul_f32 v125, v125, v127
    v_cvt_pk_bf16_f32 v91, v124, v125

    v_lshlrev_b32 v123, 16, v35
    v_mul_f32 v124, v115, v120
    v_fmac_f32 v124, v114, v121
    v_fmac_f32 v124, v113, v122
    v_fmac_f32 v124, v112, v123

    v_lshlrev_b32 v120, 16, v36
    v_mul_f32 v125, v115, v121
    v_fmac_f32 v125, v114, v122
    v_fmac_f32 v125, v113, v123
    v_fmac_f32 v125, v112, v120

    v_cvt_pk_bf16_f32 v126, v124, v125
    v_lshlrev_b32 v124, 16, v126
    v_and_b32 v125, 0xffff0000, v126

    v_lshlrev_b32 v126, 16, v68
    v_lshlrev_b32 v127, 16, v69
    v_mul_f32 v124, v124, v126
    v_mul_f32 v125, v125, v127
    v_cvt_pk_bf16_f32 v92, v124, v125

    v_lshlrev_b32 v121, 16, v37
    v_mul_f32 v124, v115, v122
    v_fmac_f32 v124, v114, v123
    v_fmac_f32 v124, v113, v120
    v_fmac_f32 v124, v112, v121

    v_lshlrev_b32 v122, 16, v38
    v_mul_f32 v125, v115, v123
    v_fmac_f32 v125, v114, v120
    v_fmac_f32 v125, v113, v121
    v_fmac_f32 v125, v112, v122

    v_cvt_pk_bf16_f32 v126, v124, v125
    v_lshlrev_b32 v124, 16, v126
    v_and_b32 v125, 0xffff0000, v126

    v_lshlrev_b32 v126, 16, v70
    v_lshlrev_b32 v127, 16, v71
    v_mul_f32 v124, v124, v126
    v_mul_f32 v125, v125, v127
    v_cvt_pk_bf16_f32 v93, v124, v125

    v_lshlrev_b32 v123, 16, v39
    v_mul_f32 v124, v115, v120
    v_fmac_f32 v124, v114, v121
    v_fmac_f32 v124, v113, v122
    v_fmac_f32 v124, v112, v123

    v_lshlrev_b32 v120, 16, v40
    v_mul_f32 v125, v115, v121
    v_fmac_f32 v125, v114, v122
    v_fmac_f32 v125, v113, v123
    v_fmac_f32 v125, v112, v120

    v_cvt_pk_bf16_f32 v126, v124, v125
    v_lshlrev_b32 v124, 16, v126
    v_and_b32 v125, 0xffff0000, v126

    v_lshlrev_b32 v126, 16, v72
    v_lshlrev_b32 v127, 16, v73
    v_mul_f32 v124, v124, v126
    v_mul_f32 v125, v125, v127
    v_cvt_pk_bf16_f32 v94, v124, v125

    v_lshlrev_b32 v121, 16, v41
    v_mul_f32 v124, v115, v122
    v_fmac_f32 v124, v114, v123
    v_fmac_f32 v124, v113, v120
    v_fmac_f32 v124, v112, v121

    v_lshlrev_b32 v122, 16, v42
    v_mul_f32 v125, v115, v123
    v_fmac_f32 v125, v114, v120
    v_fmac_f32 v125, v113, v121
    v_fmac_f32 v125, v112, v122

    v_cvt_pk_bf16_f32 v126, v124, v125
    v_lshlrev_b32 v124, 16, v126
    v_and_b32 v125, 0xffff0000, v126

    v_lshlrev_b32 v126, 16, v74
    v_lshlrev_b32 v127, 16, v75
    v_mul_f32 v124, v124, v126
    v_mul_f32 v125, v125, v127
    v_cvt_pk_bf16_f32 v95, v124, v125

    v_and_b32 v120, 0xffff0000, v8
    v_and_b32 v121, 0xffff0000, v9
    v_and_b32 v122, 0xffff0000, v10
    v_and_b32 v123, 0xffff0000, v11
    v_mul_f32 v124, v119, v120
    v_fmac_f32 v124, v118, v121
    v_fmac_f32 v124, v117, v122
    v_fmac_f32 v124, v116, v123

    v_and_b32 v120, 0xffff0000, v12
    v_mul_f32 v125, v119, v121
    v_fmac_f32 v125, v118, v122
    v_fmac_f32 v125, v117, v123
    v_fmac_f32 v125, v116, v120

    v_cvt_pk_bf16_f32 v126, v124, v125
    v_lshlrev_b32 v124, 16, v126
    v_and_b32 v125, 0xffff0000, v126

    v_and_b32 v126, 0xffff0000, v44
    v_and_b32 v127, 0xffff0000, v45
    v_mul_f32 v124, v124, v126
    v_mul_f32 v125, v125, v127
    v_cvt_pk_bf16_f32 v96, v124, v125

    v_and_b32 v121, 0xffff0000, v13
    v_mul_f32 v124, v119, v122
    v_fmac_f32 v124, v118, v123
    v_fmac_f32 v124, v117, v120
    v_fmac_f32 v124, v116, v121

    v_and_b32 v122, 0xffff0000, v14
    v_mul_f32 v125, v119, v123
    v_fmac_f32 v125, v118, v120
    v_fmac_f32 v125, v117, v121
    v_fmac_f32 v125, v116, v122

    v_cvt_pk_bf16_f32 v126, v124, v125
    v_lshlrev_b32 v124, 16, v126
    v_and_b32 v125, 0xffff0000, v126

    v_and_b32 v126, 0xffff0000, v46
    v_and_b32 v127, 0xffff0000, v47
    v_mul_f32 v124, v124, v126
    v_mul_f32 v125, v125, v127
    v_cvt_pk_bf16_f32 v97, v124, v125

    v_and_b32 v123, 0xffff0000, v15
    v_mul_f32 v124, v119, v120
    v_fmac_f32 v124, v118, v121
    v_fmac_f32 v124, v117, v122
    v_fmac_f32 v124, v116, v123

    v_and_b32 v120, 0xffff0000, v16
    v_mul_f32 v125, v119, v121
    v_fmac_f32 v125, v118, v122
    v_fmac_f32 v125, v117, v123
    v_fmac_f32 v125, v116, v120

    v_cvt_pk_bf16_f32 v126, v124, v125
    v_lshlrev_b32 v124, 16, v126
    v_and_b32 v125, 0xffff0000, v126

    v_and_b32 v126, 0xffff0000, v48
    v_and_b32 v127, 0xffff0000, v49
    v_mul_f32 v124, v124, v126
    v_mul_f32 v125, v125, v127
    v_cvt_pk_bf16_f32 v98, v124, v125

    v_and_b32 v121, 0xffff0000, v17
    v_mul_f32 v124, v119, v122
    v_fmac_f32 v124, v118, v123
    v_fmac_f32 v124, v117, v120
    v_fmac_f32 v124, v116, v121

    v_and_b32 v122, 0xffff0000, v18
    v_mul_f32 v125, v119, v123
    v_fmac_f32 v125, v118, v120
    v_fmac_f32 v125, v117, v121
    v_fmac_f32 v125, v116, v122

    v_cvt_pk_bf16_f32 v126, v124, v125
    v_lshlrev_b32 v124, 16, v126
    v_and_b32 v125, 0xffff0000, v126

    v_and_b32 v126, 0xffff0000, v50
    v_and_b32 v127, 0xffff0000, v51
    v_mul_f32 v124, v124, v126
    v_mul_f32 v125, v125, v127
    v_cvt_pk_bf16_f32 v99, v124, v125

    v_and_b32 v123, 0xffff0000, v19
    v_mul_f32 v124, v119, v120
    v_fmac_f32 v124, v118, v121
    v_fmac_f32 v124, v117, v122
    v_fmac_f32 v124, v116, v123

    v_and_b32 v120, 0xffff0000, v20
    v_mul_f32 v125, v119, v121
    v_fmac_f32 v125, v118, v122
    v_fmac_f32 v125, v117, v123
    v_fmac_f32 v125, v116, v120

    v_cvt_pk_bf16_f32 v126, v124, v125
    v_lshlrev_b32 v124, 16, v126
    v_and_b32 v125, 0xffff0000, v126

    v_and_b32 v126, 0xffff0000, v52
    v_and_b32 v127, 0xffff0000, v53
    v_mul_f32 v124, v124, v126
    v_mul_f32 v125, v125, v127
    v_cvt_pk_bf16_f32 v100, v124, v125

    v_and_b32 v121, 0xffff0000, v21
    v_mul_f32 v124, v119, v122
    v_fmac_f32 v124, v118, v123
    v_fmac_f32 v124, v117, v120
    v_fmac_f32 v124, v116, v121

    v_and_b32 v122, 0xffff0000, v22
    v_mul_f32 v125, v119, v123
    v_fmac_f32 v125, v118, v120
    v_fmac_f32 v125, v117, v121
    v_fmac_f32 v125, v116, v122

    v_cvt_pk_bf16_f32 v126, v124, v125
    v_lshlrev_b32 v124, 16, v126
    v_and_b32 v125, 0xffff0000, v126

    v_and_b32 v126, 0xffff0000, v54
    v_and_b32 v127, 0xffff0000, v55
    v_mul_f32 v124, v124, v126
    v_mul_f32 v125, v125, v127
    v_cvt_pk_bf16_f32 v101, v124, v125

    v_and_b32 v123, 0xffff0000, v23
    v_mul_f32 v124, v119, v120
    v_fmac_f32 v124, v118, v121
    v_fmac_f32 v124, v117, v122
    v_fmac_f32 v124, v116, v123

    v_and_b32 v120, 0xffff0000, v24
    v_mul_f32 v125, v119, v121
    v_fmac_f32 v125, v118, v122
    v_fmac_f32 v125, v117, v123
    v_fmac_f32 v125, v116, v120

    v_cvt_pk_bf16_f32 v126, v124, v125
    v_lshlrev_b32 v124, 16, v126
    v_and_b32 v125, 0xffff0000, v126

    v_and_b32 v126, 0xffff0000, v56
    v_and_b32 v127, 0xffff0000, v57
    v_mul_f32 v124, v124, v126
    v_mul_f32 v125, v125, v127
    v_cvt_pk_bf16_f32 v102, v124, v125

    v_and_b32 v121, 0xffff0000, v25
    v_mul_f32 v124, v119, v122
    v_fmac_f32 v124, v118, v123
    v_fmac_f32 v124, v117, v120
    v_fmac_f32 v124, v116, v121

    v_and_b32 v122, 0xffff0000, v26
    v_mul_f32 v125, v119, v123
    v_fmac_f32 v125, v118, v120
    v_fmac_f32 v125, v117, v121
    v_fmac_f32 v125, v116, v122

    v_cvt_pk_bf16_f32 v126, v124, v125
    v_lshlrev_b32 v124, 16, v126
    v_and_b32 v125, 0xffff0000, v126

    v_and_b32 v126, 0xffff0000, v58
    v_and_b32 v127, 0xffff0000, v59
    v_mul_f32 v124, v124, v126
    v_mul_f32 v125, v125, v127
    v_cvt_pk_bf16_f32 v103, v124, v125

    v_and_b32 v123, 0xffff0000, v27
    v_mul_f32 v124, v119, v120
    v_fmac_f32 v124, v118, v121
    v_fmac_f32 v124, v117, v122
    v_fmac_f32 v124, v116, v123

    v_and_b32 v120, 0xffff0000, v28
    v_mul_f32 v125, v119, v121
    v_fmac_f32 v125, v118, v122
    v_fmac_f32 v125, v117, v123
    v_fmac_f32 v125, v116, v120

    v_cvt_pk_bf16_f32 v126, v124, v125
    v_lshlrev_b32 v124, 16, v126
    v_and_b32 v125, 0xffff0000, v126

    v_and_b32 v126, 0xffff0000, v60
    v_and_b32 v127, 0xffff0000, v61
    v_mul_f32 v124, v124, v126
    v_mul_f32 v125, v125, v127
    v_cvt_pk_bf16_f32 v104, v124, v125

    v_and_b32 v121, 0xffff0000, v29
    v_mul_f32 v124, v119, v122
    v_fmac_f32 v124, v118, v123
    v_fmac_f32 v124, v117, v120
    v_fmac_f32 v124, v116, v121

    v_and_b32 v122, 0xffff0000, v30
    v_mul_f32 v125, v119, v123
    v_fmac_f32 v125, v118, v120
    v_fmac_f32 v125, v117, v121
    v_fmac_f32 v125, v116, v122

    v_cvt_pk_bf16_f32 v126, v124, v125
    v_lshlrev_b32 v124, 16, v126
    v_and_b32 v125, 0xffff0000, v126

    v_and_b32 v126, 0xffff0000, v62
    v_and_b32 v127, 0xffff0000, v63
    v_mul_f32 v124, v124, v126
    v_mul_f32 v125, v125, v127
    v_cvt_pk_bf16_f32 v105, v124, v125

    v_and_b32 v123, 0xffff0000, v31
    v_mul_f32 v124, v119, v120
    v_fmac_f32 v124, v118, v121
    v_fmac_f32 v124, v117, v122
    v_fmac_f32 v124, v116, v123

    v_and_b32 v120, 0xffff0000, v32
    v_mul_f32 v125, v119, v121
    v_fmac_f32 v125, v118, v122
    v_fmac_f32 v125, v117, v123
    v_fmac_f32 v125, v116, v120

    v_cvt_pk_bf16_f32 v126, v124, v125
    v_lshlrev_b32 v124, 16, v126
    v_and_b32 v125, 0xffff0000, v126

    v_and_b32 v126, 0xffff0000, v64
    v_and_b32 v127, 0xffff0000, v65
    v_mul_f32 v124, v124, v126
    v_mul_f32 v125, v125, v127
    v_cvt_pk_bf16_f32 v106, v124, v125

    v_and_b32 v121, 0xffff0000, v33
    v_mul_f32 v124, v119, v122
    v_fmac_f32 v124, v118, v123
    v_fmac_f32 v124, v117, v120
    v_fmac_f32 v124, v116, v121

    v_and_b32 v122, 0xffff0000, v34
    v_mul_f32 v125, v119, v123
    v_fmac_f32 v125, v118, v120
    v_fmac_f32 v125, v117, v121
    v_fmac_f32 v125, v116, v122

    v_cvt_pk_bf16_f32 v126, v124, v125
    v_lshlrev_b32 v124, 16, v126
    v_and_b32 v125, 0xffff0000, v126

    v_and_b32 v126, 0xffff0000, v66
    v_and_b32 v127, 0xffff0000, v67
    v_mul_f32 v124, v124, v126
    v_mul_f32 v125, v125, v127
    v_cvt_pk_bf16_f32 v107, v124, v125

    v_and_b32 v123, 0xffff0000, v35
    v_mul_f32 v124, v119, v120
    v_fmac_f32 v124, v118, v121
    v_fmac_f32 v124, v117, v122
    v_fmac_f32 v124, v116, v123

    v_and_b32 v120, 0xffff0000, v36
    v_mul_f32 v125, v119, v121
    v_fmac_f32 v125, v118, v122
    v_fmac_f32 v125, v117, v123
    v_fmac_f32 v125, v116, v120

    v_cvt_pk_bf16_f32 v126, v124, v125
    v_lshlrev_b32 v124, 16, v126
    v_and_b32 v125, 0xffff0000, v126

    v_and_b32 v126, 0xffff0000, v68
    v_and_b32 v127, 0xffff0000, v69
    v_mul_f32 v124, v124, v126
    v_mul_f32 v125, v125, v127
    v_cvt_pk_bf16_f32 v108, v124, v125

    v_and_b32 v121, 0xffff0000, v37
    v_mul_f32 v124, v119, v122
    v_fmac_f32 v124, v118, v123
    v_fmac_f32 v124, v117, v120
    v_fmac_f32 v124, v116, v121

    v_and_b32 v122, 0xffff0000, v38
    v_mul_f32 v125, v119, v123
    v_fmac_f32 v125, v118, v120
    v_fmac_f32 v125, v117, v121
    v_fmac_f32 v125, v116, v122

    v_cvt_pk_bf16_f32 v126, v124, v125
    v_lshlrev_b32 v124, 16, v126
    v_and_b32 v125, 0xffff0000, v126

    v_and_b32 v126, 0xffff0000, v70
    v_and_b32 v127, 0xffff0000, v71
    v_mul_f32 v124, v124, v126
    v_mul_f32 v125, v125, v127
    v_cvt_pk_bf16_f32 v109, v124, v125

    v_and_b32 v123, 0xffff0000, v39
    v_mul_f32 v124, v119, v120
    v_fmac_f32 v124, v118, v121
    v_fmac_f32 v124, v117, v122
    v_fmac_f32 v124, v116, v123

    v_and_b32 v120, 0xffff0000, v40
    v_mul_f32 v125, v119, v121
    v_fmac_f32 v125, v118, v122
    v_fmac_f32 v125, v117, v123
    v_fmac_f32 v125, v116, v120

    v_cvt_pk_bf16_f32 v126, v124, v125
    v_lshlrev_b32 v124, 16, v126
    v_and_b32 v125, 0xffff0000, v126

    v_and_b32 v126, 0xffff0000, v72
    v_and_b32 v127, 0xffff0000, v73
    v_mul_f32 v124, v124, v126
    v_mul_f32 v125, v125, v127
    v_cvt_pk_bf16_f32 v110, v124, v125

    v_and_b32 v121, 0xffff0000, v41
    v_mul_f32 v124, v119, v122
    v_fmac_f32 v124, v118, v123
    v_fmac_f32 v124, v117, v120
    v_fmac_f32 v124, v116, v121

    v_and_b32 v122, 0xffff0000, v42
    v_mul_f32 v125, v119, v123
    v_fmac_f32 v125, v118, v120
    v_fmac_f32 v125, v117, v121
    v_fmac_f32 v125, v116, v122

    v_cvt_pk_bf16_f32 v126, v124, v125
    v_lshlrev_b32 v124, 16, v126
    v_and_b32 v125, 0xffff0000, v126

    v_and_b32 v126, 0xffff0000, v74
    v_and_b32 v127, 0xffff0000, v75
    v_mul_f32 v124, v124, v126
    v_mul_f32 v125, v125, v127
    v_cvt_pk_bf16_f32 v111, v124, v125

    v_lshlrev_b32 v5, 13, v1
    s_lshl_b32 s36, s33, 19
    s_lshl_b32 s37, s32, 6
    s_add_u32 s36, s36, s37
    s_add_u32 s36, s36, 12582912
    s_add_u32 s37, s36, 4096

    buffer_store_dwordx4 v[80:83], v5, s[28:31], s36 offen offset:0
    buffer_store_dwordx4 v[84:87], v5, s[28:31], s36 offen offset:16
    buffer_store_dwordx4 v[88:91], v5, s[28:31], s36 offen offset:32
    buffer_store_dwordx4 v[92:95], v5, s[28:31], s36 offen offset:48
    buffer_store_dwordx4 v[96:99], v5, s[28:31], s37 offen offset:0
    buffer_store_dwordx4 v[100:103], v5, s[28:31], s37 offen offset:16
    buffer_store_dwordx4 v[104:107], v5, s[28:31], s37 offen offset:32
    buffer_store_dwordx4 v[108:111], v5, s[28:31], s37 offen offset:48
    s_endpgm
Lnext_4:
    s_sub_u32 s2, s2, 64
    s_load_dwordx2 s[4:5], s[0:1], 0
    s_load_dwordx2 s[6:7], s[0:1], 72
    s_load_dwordx2 s[8:9], s[0:1], 96
    v_and_b32 v1, 63, v0
    v_lshrrev_b32 v2, 6, v0
    s_nop 0
    v_readfirstlane_b32 s26, v2
    s_waitcnt lgkmcnt(0)
    s_mov_b32 s12, s4
    s_mov_b32 s13, s5
    s_mov_b32 s14, 2097152
    s_mov_b32 s15, 0x00020000
    s_mov_b32 s16, s6
    s_mov_b32 s17, s7
    s_mov_b32 s18, 1024
    s_mov_b32 s19, 0x00020000
    s_mov_b32 s20, s8
    s_mov_b32 s21, s9
    s_mov_b32 s22, 16777216
    s_mov_b32 s23, 0x00020000
    s_lshl_b32 s27, s2, 2
    s_add_u32 s27, s27, s26
    s_lshl_b32 s27, s27, 3
    v_lshlrev_b32 v3, 4, v1
    buffer_load_dwordx4 v[4:7], v3, s[16:19], 0 offen

    s_add_u32 s28, s27, 0
    s_lshl_b32 s28, s28, 10
    buffer_load_dwordx4 v[16:19], v3, s[12:15], s28 offen
    s_add_u32 s28, s27, 1
    s_lshl_b32 s28, s28, 10
    buffer_load_dwordx4 v[20:23], v3, s[12:15], s28 offen
    s_add_u32 s28, s27, 2
    s_lshl_b32 s28, s28, 10
    buffer_load_dwordx4 v[24:27], v3, s[12:15], s28 offen
    s_add_u32 s28, s27, 3
    s_lshl_b32 s28, s28, 10
    buffer_load_dwordx4 v[28:31], v3, s[12:15], s28 offen
    s_add_u32 s28, s27, 4
    s_lshl_b32 s28, s28, 10
    buffer_load_dwordx4 v[32:35], v3, s[12:15], s28 offen
    s_add_u32 s28, s27, 5
    s_lshl_b32 s28, s28, 10
    buffer_load_dwordx4 v[36:39], v3, s[12:15], s28 offen
    s_add_u32 s28, s27, 6
    s_lshl_b32 s28, s28, 10
    buffer_load_dwordx4 v[40:43], v3, s[12:15], s28 offen
    s_add_u32 s28, s27, 7
    s_lshl_b32 s28, s28, 10
    buffer_load_dwordx4 v[44:47], v3, s[12:15], s28 offen
    s_waitcnt vmcnt(0)
    v_lshlrev_b32 v8, 16, v4
    v_and_b32 v9, 0xffff0000, v4
    v_lshlrev_b32 v10, 16, v5
    v_and_b32 v11, 0xffff0000, v5
    v_lshlrev_b32 v12, 16, v6
    v_and_b32 v13, 0xffff0000, v6
    v_lshlrev_b32 v14, 16, v7
    v_and_b32 v15, 0xffff0000, v7
    v_mov_b32 v50, 0
    v_lshlrev_b32 v48, 16, v16
    v_and_b32 v49, 0xffff0000, v16
    v_mul_f32 v48, v48, v8
    v_mul_f32 v49, v49, v9
    v_cvt_pk_bf16_f32 v51, v48, v49
    v_lshlrev_b32 v48, 16, v51
    v_and_b32 v49, 0xffff0000, v51
    v_add_f32 v50, v50, v48
    v_add_f32 v50, v50, v49

    v_lshlrev_b32 v48, 16, v17
    v_and_b32 v49, 0xffff0000, v17
    v_mul_f32 v48, v48, v10
    v_mul_f32 v49, v49, v11
    v_cvt_pk_bf16_f32 v51, v48, v49
    v_lshlrev_b32 v48, 16, v51
    v_and_b32 v49, 0xffff0000, v51
    v_add_f32 v50, v50, v48
    v_add_f32 v50, v50, v49

    v_lshlrev_b32 v48, 16, v18
    v_and_b32 v49, 0xffff0000, v18
    v_mul_f32 v48, v48, v12
    v_mul_f32 v49, v49, v13
    v_cvt_pk_bf16_f32 v51, v48, v49
    v_lshlrev_b32 v48, 16, v51
    v_and_b32 v49, 0xffff0000, v51
    v_add_f32 v50, v50, v48
    v_add_f32 v50, v50, v49

    v_lshlrev_b32 v48, 16, v19
    v_and_b32 v49, 0xffff0000, v19
    v_mul_f32 v48, v48, v14
    v_mul_f32 v49, v49, v15
    v_cvt_pk_bf16_f32 v51, v48, v49
    v_lshlrev_b32 v48, 16, v51
    v_and_b32 v49, 0xffff0000, v51
    v_add_f32 v50, v50, v48
    v_add_f32 v50, v50, v49

    v_mov_b32 v51, v50
    s_nop 1
    v_permlane32_swap_b32 v50, v51
    v_add_f32 v50, v50, v51
    v_mov_b32 v51, v50
    s_nop 1
    v_permlane16_swap_b32 v50, v51
    v_add_f32 v50, v50, v51
    s_nop 1
    v_add_f32_dpp v50, v50, v50 row_ror:8 row_mask:0xf bank_mask:0xf
    s_nop 1
    v_add_f32_dpp v50, v50, v50 row_ror:4 row_mask:0xf bank_mask:0xf
    s_nop 1
    v_add_f32_dpp v50, v50, v50 row_ror:2 row_mask:0xf bank_mask:0xf
    s_nop 1
    v_add_f32_dpp v50, v50, v50 row_ror:1 row_mask:0xf bank_mask:0xf
    v_cvt_pk_bf16_f32 v50, v50, v50
    v_lshlrev_b32 v50, 16, v50
    v_mul_f32 v50, 0xbfb8aa3b, v50
    v_exp_f32 v50, v50
    s_nop 0
    v_add_f32 v50, 1.0, v50
    v_rcp_f32 v50, v50
    s_nop 0
    v_cvt_pk_bf16_f32 v50, v50, v50
    v_lshlrev_b32 v50, 16, v50

    v_cmp_eq_u32 vcc, 0, v1
    s_nop 1
    v_cndmask_b32 v52, v52, v50, vcc
    v_mov_b32 v50, 0
    v_lshlrev_b32 v48, 16, v20
    v_and_b32 v49, 0xffff0000, v20
    v_mul_f32 v48, v48, v8
    v_mul_f32 v49, v49, v9
    v_cvt_pk_bf16_f32 v51, v48, v49
    v_lshlrev_b32 v48, 16, v51
    v_and_b32 v49, 0xffff0000, v51
    v_add_f32 v50, v50, v48
    v_add_f32 v50, v50, v49

    v_lshlrev_b32 v48, 16, v21
    v_and_b32 v49, 0xffff0000, v21
    v_mul_f32 v48, v48, v10
    v_mul_f32 v49, v49, v11
    v_cvt_pk_bf16_f32 v51, v48, v49
    v_lshlrev_b32 v48, 16, v51
    v_and_b32 v49, 0xffff0000, v51
    v_add_f32 v50, v50, v48
    v_add_f32 v50, v50, v49

    v_lshlrev_b32 v48, 16, v22
    v_and_b32 v49, 0xffff0000, v22
    v_mul_f32 v48, v48, v12
    v_mul_f32 v49, v49, v13
    v_cvt_pk_bf16_f32 v51, v48, v49
    v_lshlrev_b32 v48, 16, v51
    v_and_b32 v49, 0xffff0000, v51
    v_add_f32 v50, v50, v48
    v_add_f32 v50, v50, v49

    v_lshlrev_b32 v48, 16, v23
    v_and_b32 v49, 0xffff0000, v23
    v_mul_f32 v48, v48, v14
    v_mul_f32 v49, v49, v15
    v_cvt_pk_bf16_f32 v51, v48, v49
    v_lshlrev_b32 v48, 16, v51
    v_and_b32 v49, 0xffff0000, v51
    v_add_f32 v50, v50, v48
    v_add_f32 v50, v50, v49

    v_mov_b32 v51, v50
    s_nop 1
    v_permlane32_swap_b32 v50, v51
    v_add_f32 v50, v50, v51
    v_mov_b32 v51, v50
    s_nop 1
    v_permlane16_swap_b32 v50, v51
    v_add_f32 v50, v50, v51
    s_nop 1
    v_add_f32_dpp v50, v50, v50 row_ror:8 row_mask:0xf bank_mask:0xf
    s_nop 1
    v_add_f32_dpp v50, v50, v50 row_ror:4 row_mask:0xf bank_mask:0xf
    s_nop 1
    v_add_f32_dpp v50, v50, v50 row_ror:2 row_mask:0xf bank_mask:0xf
    s_nop 1
    v_add_f32_dpp v50, v50, v50 row_ror:1 row_mask:0xf bank_mask:0xf
    v_cvt_pk_bf16_f32 v50, v50, v50
    v_lshlrev_b32 v50, 16, v50
    v_mul_f32 v50, 0xbfb8aa3b, v50
    v_exp_f32 v50, v50
    s_nop 0
    v_add_f32 v50, 1.0, v50
    v_rcp_f32 v50, v50
    s_nop 0
    v_cvt_pk_bf16_f32 v50, v50, v50
    v_lshlrev_b32 v50, 16, v50

    v_cmp_eq_u32 vcc, 1, v1
    s_nop 1
    v_cndmask_b32 v52, v52, v50, vcc
    v_mov_b32 v50, 0
    v_lshlrev_b32 v48, 16, v24
    v_and_b32 v49, 0xffff0000, v24
    v_mul_f32 v48, v48, v8
    v_mul_f32 v49, v49, v9
    v_cvt_pk_bf16_f32 v51, v48, v49
    v_lshlrev_b32 v48, 16, v51
    v_and_b32 v49, 0xffff0000, v51
    v_add_f32 v50, v50, v48
    v_add_f32 v50, v50, v49

    v_lshlrev_b32 v48, 16, v25
    v_and_b32 v49, 0xffff0000, v25
    v_mul_f32 v48, v48, v10
    v_mul_f32 v49, v49, v11
    v_cvt_pk_bf16_f32 v51, v48, v49
    v_lshlrev_b32 v48, 16, v51
    v_and_b32 v49, 0xffff0000, v51
    v_add_f32 v50, v50, v48
    v_add_f32 v50, v50, v49

    v_lshlrev_b32 v48, 16, v26
    v_and_b32 v49, 0xffff0000, v26
    v_mul_f32 v48, v48, v12
    v_mul_f32 v49, v49, v13
    v_cvt_pk_bf16_f32 v51, v48, v49
    v_lshlrev_b32 v48, 16, v51
    v_and_b32 v49, 0xffff0000, v51
    v_add_f32 v50, v50, v48
    v_add_f32 v50, v50, v49

    v_lshlrev_b32 v48, 16, v27
    v_and_b32 v49, 0xffff0000, v27
    v_mul_f32 v48, v48, v14
    v_mul_f32 v49, v49, v15
    v_cvt_pk_bf16_f32 v51, v48, v49
    v_lshlrev_b32 v48, 16, v51
    v_and_b32 v49, 0xffff0000, v51
    v_add_f32 v50, v50, v48
    v_add_f32 v50, v50, v49

    v_mov_b32 v51, v50
    s_nop 1
    v_permlane32_swap_b32 v50, v51
    v_add_f32 v50, v50, v51
    v_mov_b32 v51, v50
    s_nop 1
    v_permlane16_swap_b32 v50, v51
    v_add_f32 v50, v50, v51
    s_nop 1
    v_add_f32_dpp v50, v50, v50 row_ror:8 row_mask:0xf bank_mask:0xf
    s_nop 1
    v_add_f32_dpp v50, v50, v50 row_ror:4 row_mask:0xf bank_mask:0xf
    s_nop 1
    v_add_f32_dpp v50, v50, v50 row_ror:2 row_mask:0xf bank_mask:0xf
    s_nop 1
    v_add_f32_dpp v50, v50, v50 row_ror:1 row_mask:0xf bank_mask:0xf
    v_cvt_pk_bf16_f32 v50, v50, v50
    v_lshlrev_b32 v50, 16, v50
    v_mul_f32 v50, 0xbfb8aa3b, v50
    v_exp_f32 v50, v50
    s_nop 0
    v_add_f32 v50, 1.0, v50
    v_rcp_f32 v50, v50
    s_nop 0
    v_cvt_pk_bf16_f32 v50, v50, v50
    v_lshlrev_b32 v50, 16, v50

    v_cmp_eq_u32 vcc, 2, v1
    s_nop 1
    v_cndmask_b32 v52, v52, v50, vcc
    v_mov_b32 v50, 0
    v_lshlrev_b32 v48, 16, v28
    v_and_b32 v49, 0xffff0000, v28
    v_mul_f32 v48, v48, v8
    v_mul_f32 v49, v49, v9
    v_cvt_pk_bf16_f32 v51, v48, v49
    v_lshlrev_b32 v48, 16, v51
    v_and_b32 v49, 0xffff0000, v51
    v_add_f32 v50, v50, v48
    v_add_f32 v50, v50, v49

    v_lshlrev_b32 v48, 16, v29
    v_and_b32 v49, 0xffff0000, v29
    v_mul_f32 v48, v48, v10
    v_mul_f32 v49, v49, v11
    v_cvt_pk_bf16_f32 v51, v48, v49
    v_lshlrev_b32 v48, 16, v51
    v_and_b32 v49, 0xffff0000, v51
    v_add_f32 v50, v50, v48
    v_add_f32 v50, v50, v49

    v_lshlrev_b32 v48, 16, v30
    v_and_b32 v49, 0xffff0000, v30
    v_mul_f32 v48, v48, v12
    v_mul_f32 v49, v49, v13
    v_cvt_pk_bf16_f32 v51, v48, v49
    v_lshlrev_b32 v48, 16, v51
    v_and_b32 v49, 0xffff0000, v51
    v_add_f32 v50, v50, v48
    v_add_f32 v50, v50, v49

    v_lshlrev_b32 v48, 16, v31
    v_and_b32 v49, 0xffff0000, v31
    v_mul_f32 v48, v48, v14
    v_mul_f32 v49, v49, v15
    v_cvt_pk_bf16_f32 v51, v48, v49
    v_lshlrev_b32 v48, 16, v51
    v_and_b32 v49, 0xffff0000, v51
    v_add_f32 v50, v50, v48
    v_add_f32 v50, v50, v49

    v_mov_b32 v51, v50
    s_nop 1
    v_permlane32_swap_b32 v50, v51
    v_add_f32 v50, v50, v51
    v_mov_b32 v51, v50
    s_nop 1
    v_permlane16_swap_b32 v50, v51
    v_add_f32 v50, v50, v51
    s_nop 1
    v_add_f32_dpp v50, v50, v50 row_ror:8 row_mask:0xf bank_mask:0xf
    s_nop 1
    v_add_f32_dpp v50, v50, v50 row_ror:4 row_mask:0xf bank_mask:0xf
    s_nop 1
    v_add_f32_dpp v50, v50, v50 row_ror:2 row_mask:0xf bank_mask:0xf
    s_nop 1
    v_add_f32_dpp v50, v50, v50 row_ror:1 row_mask:0xf bank_mask:0xf
    v_cvt_pk_bf16_f32 v50, v50, v50
    v_lshlrev_b32 v50, 16, v50
    v_mul_f32 v50, 0xbfb8aa3b, v50
    v_exp_f32 v50, v50
    s_nop 0
    v_add_f32 v50, 1.0, v50
    v_rcp_f32 v50, v50
    s_nop 0
    v_cvt_pk_bf16_f32 v50, v50, v50
    v_lshlrev_b32 v50, 16, v50

    v_cmp_eq_u32 vcc, 3, v1
    s_nop 1
    v_cndmask_b32 v52, v52, v50, vcc
    v_mov_b32 v50, 0
    v_lshlrev_b32 v48, 16, v32
    v_and_b32 v49, 0xffff0000, v32
    v_mul_f32 v48, v48, v8
    v_mul_f32 v49, v49, v9
    v_cvt_pk_bf16_f32 v51, v48, v49
    v_lshlrev_b32 v48, 16, v51
    v_and_b32 v49, 0xffff0000, v51
    v_add_f32 v50, v50, v48
    v_add_f32 v50, v50, v49

    v_lshlrev_b32 v48, 16, v33
    v_and_b32 v49, 0xffff0000, v33
    v_mul_f32 v48, v48, v10
    v_mul_f32 v49, v49, v11
    v_cvt_pk_bf16_f32 v51, v48, v49
    v_lshlrev_b32 v48, 16, v51
    v_and_b32 v49, 0xffff0000, v51
    v_add_f32 v50, v50, v48
    v_add_f32 v50, v50, v49

    v_lshlrev_b32 v48, 16, v34
    v_and_b32 v49, 0xffff0000, v34
    v_mul_f32 v48, v48, v12
    v_mul_f32 v49, v49, v13
    v_cvt_pk_bf16_f32 v51, v48, v49
    v_lshlrev_b32 v48, 16, v51
    v_and_b32 v49, 0xffff0000, v51
    v_add_f32 v50, v50, v48
    v_add_f32 v50, v50, v49

    v_lshlrev_b32 v48, 16, v35
    v_and_b32 v49, 0xffff0000, v35
    v_mul_f32 v48, v48, v14
    v_mul_f32 v49, v49, v15
    v_cvt_pk_bf16_f32 v51, v48, v49
    v_lshlrev_b32 v48, 16, v51
    v_and_b32 v49, 0xffff0000, v51
    v_add_f32 v50, v50, v48
    v_add_f32 v50, v50, v49

    v_mov_b32 v51, v50
    s_nop 1
    v_permlane32_swap_b32 v50, v51
    v_add_f32 v50, v50, v51
    v_mov_b32 v51, v50
    s_nop 1
    v_permlane16_swap_b32 v50, v51
    v_add_f32 v50, v50, v51
    s_nop 1
    v_add_f32_dpp v50, v50, v50 row_ror:8 row_mask:0xf bank_mask:0xf
    s_nop 1
    v_add_f32_dpp v50, v50, v50 row_ror:4 row_mask:0xf bank_mask:0xf
    s_nop 1
    v_add_f32_dpp v50, v50, v50 row_ror:2 row_mask:0xf bank_mask:0xf
    s_nop 1
    v_add_f32_dpp v50, v50, v50 row_ror:1 row_mask:0xf bank_mask:0xf
    v_cvt_pk_bf16_f32 v50, v50, v50
    v_lshlrev_b32 v50, 16, v50
    v_mul_f32 v50, 0xbfb8aa3b, v50
    v_exp_f32 v50, v50
    s_nop 0
    v_add_f32 v50, 1.0, v50
    v_rcp_f32 v50, v50
    s_nop 0
    v_cvt_pk_bf16_f32 v50, v50, v50
    v_lshlrev_b32 v50, 16, v50

    v_cmp_eq_u32 vcc, 4, v1
    s_nop 1
    v_cndmask_b32 v52, v52, v50, vcc
    v_mov_b32 v50, 0
    v_lshlrev_b32 v48, 16, v36
    v_and_b32 v49, 0xffff0000, v36
    v_mul_f32 v48, v48, v8
    v_mul_f32 v49, v49, v9
    v_cvt_pk_bf16_f32 v51, v48, v49
    v_lshlrev_b32 v48, 16, v51
    v_and_b32 v49, 0xffff0000, v51
    v_add_f32 v50, v50, v48
    v_add_f32 v50, v50, v49

    v_lshlrev_b32 v48, 16, v37
    v_and_b32 v49, 0xffff0000, v37
    v_mul_f32 v48, v48, v10
    v_mul_f32 v49, v49, v11
    v_cvt_pk_bf16_f32 v51, v48, v49
    v_lshlrev_b32 v48, 16, v51
    v_and_b32 v49, 0xffff0000, v51
    v_add_f32 v50, v50, v48
    v_add_f32 v50, v50, v49

    v_lshlrev_b32 v48, 16, v38
    v_and_b32 v49, 0xffff0000, v38
    v_mul_f32 v48, v48, v12
    v_mul_f32 v49, v49, v13
    v_cvt_pk_bf16_f32 v51, v48, v49
    v_lshlrev_b32 v48, 16, v51
    v_and_b32 v49, 0xffff0000, v51
    v_add_f32 v50, v50, v48
    v_add_f32 v50, v50, v49

    v_lshlrev_b32 v48, 16, v39
    v_and_b32 v49, 0xffff0000, v39
    v_mul_f32 v48, v48, v14
    v_mul_f32 v49, v49, v15
    v_cvt_pk_bf16_f32 v51, v48, v49
    v_lshlrev_b32 v48, 16, v51
    v_and_b32 v49, 0xffff0000, v51
    v_add_f32 v50, v50, v48
    v_add_f32 v50, v50, v49

    v_mov_b32 v51, v50
    s_nop 1
    v_permlane32_swap_b32 v50, v51
    v_add_f32 v50, v50, v51
    v_mov_b32 v51, v50
    s_nop 1
    v_permlane16_swap_b32 v50, v51
    v_add_f32 v50, v50, v51
    s_nop 1
    v_add_f32_dpp v50, v50, v50 row_ror:8 row_mask:0xf bank_mask:0xf
    s_nop 1
    v_add_f32_dpp v50, v50, v50 row_ror:4 row_mask:0xf bank_mask:0xf
    s_nop 1
    v_add_f32_dpp v50, v50, v50 row_ror:2 row_mask:0xf bank_mask:0xf
    s_nop 1
    v_add_f32_dpp v50, v50, v50 row_ror:1 row_mask:0xf bank_mask:0xf
    v_cvt_pk_bf16_f32 v50, v50, v50
    v_lshlrev_b32 v50, 16, v50
    v_mul_f32 v50, 0xbfb8aa3b, v50
    v_exp_f32 v50, v50
    s_nop 0
    v_add_f32 v50, 1.0, v50
    v_rcp_f32 v50, v50
    s_nop 0
    v_cvt_pk_bf16_f32 v50, v50, v50
    v_lshlrev_b32 v50, 16, v50

    v_cmp_eq_u32 vcc, 5, v1
    s_nop 1
    v_cndmask_b32 v52, v52, v50, vcc
    v_mov_b32 v50, 0
    v_lshlrev_b32 v48, 16, v40
    v_and_b32 v49, 0xffff0000, v40
    v_mul_f32 v48, v48, v8
    v_mul_f32 v49, v49, v9
    v_cvt_pk_bf16_f32 v51, v48, v49
    v_lshlrev_b32 v48, 16, v51
    v_and_b32 v49, 0xffff0000, v51
    v_add_f32 v50, v50, v48
    v_add_f32 v50, v50, v49

    v_lshlrev_b32 v48, 16, v41
    v_and_b32 v49, 0xffff0000, v41
    v_mul_f32 v48, v48, v10
    v_mul_f32 v49, v49, v11
    v_cvt_pk_bf16_f32 v51, v48, v49
    v_lshlrev_b32 v48, 16, v51
    v_and_b32 v49, 0xffff0000, v51
    v_add_f32 v50, v50, v48
    v_add_f32 v50, v50, v49

    v_lshlrev_b32 v48, 16, v42
    v_and_b32 v49, 0xffff0000, v42
    v_mul_f32 v48, v48, v12
    v_mul_f32 v49, v49, v13
    v_cvt_pk_bf16_f32 v51, v48, v49
    v_lshlrev_b32 v48, 16, v51
    v_and_b32 v49, 0xffff0000, v51
    v_add_f32 v50, v50, v48
    v_add_f32 v50, v50, v49

    v_lshlrev_b32 v48, 16, v43
    v_and_b32 v49, 0xffff0000, v43
    v_mul_f32 v48, v48, v14
    v_mul_f32 v49, v49, v15
    v_cvt_pk_bf16_f32 v51, v48, v49
    v_lshlrev_b32 v48, 16, v51
    v_and_b32 v49, 0xffff0000, v51
    v_add_f32 v50, v50, v48
    v_add_f32 v50, v50, v49

    v_mov_b32 v51, v50
    s_nop 1
    v_permlane32_swap_b32 v50, v51
    v_add_f32 v50, v50, v51
    v_mov_b32 v51, v50
    s_nop 1
    v_permlane16_swap_b32 v50, v51
    v_add_f32 v50, v50, v51
    s_nop 1
    v_add_f32_dpp v50, v50, v50 row_ror:8 row_mask:0xf bank_mask:0xf
    s_nop 1
    v_add_f32_dpp v50, v50, v50 row_ror:4 row_mask:0xf bank_mask:0xf
    s_nop 1
    v_add_f32_dpp v50, v50, v50 row_ror:2 row_mask:0xf bank_mask:0xf
    s_nop 1
    v_add_f32_dpp v50, v50, v50 row_ror:1 row_mask:0xf bank_mask:0xf
    v_cvt_pk_bf16_f32 v50, v50, v50
    v_lshlrev_b32 v50, 16, v50
    v_mul_f32 v50, 0xbfb8aa3b, v50
    v_exp_f32 v50, v50
    s_nop 0
    v_add_f32 v50, 1.0, v50
    v_rcp_f32 v50, v50
    s_nop 0
    v_cvt_pk_bf16_f32 v50, v50, v50
    v_lshlrev_b32 v50, 16, v50

    v_cmp_eq_u32 vcc, 6, v1
    s_nop 1
    v_cndmask_b32 v52, v52, v50, vcc
    v_mov_b32 v50, 0
    v_lshlrev_b32 v48, 16, v44
    v_and_b32 v49, 0xffff0000, v44
    v_mul_f32 v48, v48, v8
    v_mul_f32 v49, v49, v9
    v_cvt_pk_bf16_f32 v51, v48, v49
    v_lshlrev_b32 v48, 16, v51
    v_and_b32 v49, 0xffff0000, v51
    v_add_f32 v50, v50, v48
    v_add_f32 v50, v50, v49

    v_lshlrev_b32 v48, 16, v45
    v_and_b32 v49, 0xffff0000, v45
    v_mul_f32 v48, v48, v10
    v_mul_f32 v49, v49, v11
    v_cvt_pk_bf16_f32 v51, v48, v49
    v_lshlrev_b32 v48, 16, v51
    v_and_b32 v49, 0xffff0000, v51
    v_add_f32 v50, v50, v48
    v_add_f32 v50, v50, v49

    v_lshlrev_b32 v48, 16, v46
    v_and_b32 v49, 0xffff0000, v46
    v_mul_f32 v48, v48, v12
    v_mul_f32 v49, v49, v13
    v_cvt_pk_bf16_f32 v51, v48, v49
    v_lshlrev_b32 v48, 16, v51
    v_and_b32 v49, 0xffff0000, v51
    v_add_f32 v50, v50, v48
    v_add_f32 v50, v50, v49

    v_lshlrev_b32 v48, 16, v47
    v_and_b32 v49, 0xffff0000, v47
    v_mul_f32 v48, v48, v14
    v_mul_f32 v49, v49, v15
    v_cvt_pk_bf16_f32 v51, v48, v49
    v_lshlrev_b32 v48, 16, v51
    v_and_b32 v49, 0xffff0000, v51
    v_add_f32 v50, v50, v48
    v_add_f32 v50, v50, v49

    v_mov_b32 v51, v50
    s_nop 1
    v_permlane32_swap_b32 v50, v51
    v_add_f32 v50, v50, v51
    v_mov_b32 v51, v50
    s_nop 1
    v_permlane16_swap_b32 v50, v51
    v_add_f32 v50, v50, v51
    s_nop 1
    v_add_f32_dpp v50, v50, v50 row_ror:8 row_mask:0xf bank_mask:0xf
    s_nop 1
    v_add_f32_dpp v50, v50, v50 row_ror:4 row_mask:0xf bank_mask:0xf
    s_nop 1
    v_add_f32_dpp v50, v50, v50 row_ror:2 row_mask:0xf bank_mask:0xf
    s_nop 1
    v_add_f32_dpp v50, v50, v50 row_ror:1 row_mask:0xf bank_mask:0xf
    v_cvt_pk_bf16_f32 v50, v50, v50
    v_lshlrev_b32 v50, 16, v50
    v_mul_f32 v50, 0xbfb8aa3b, v50
    v_exp_f32 v50, v50
    s_nop 0
    v_add_f32 v50, 1.0, v50
    v_rcp_f32 v50, v50
    s_nop 0
    v_cvt_pk_bf16_f32 v50, v50, v50
    v_lshlrev_b32 v50, 16, v50

    v_cmp_eq_u32 vcc, 7, v1
    s_nop 1
    v_cndmask_b32 v52, v52, v50, vcc
    v_cmp_gt_u32 vcc, 8, v1
    s_and_saveexec_b64 s[30:31], vcc
    v_lshlrev_b32 v3, 2, v1
    s_lshl_b32 s28, s27, 2
    s_add_u32 s28, s28, 10485760
    buffer_store_dword v52, v3, s[20:23], s28 offen
    s_mov_b64 exec, s[30:31]

    s_endpgm
Lexit_k1_kernel:
    s_endpgm
.globl k2_kernel
.p2align 8
.type k2_kernel,@function
k2_kernel:

    s_cmp_ge_u32 s2, 1536
    s_cbranch_scc1 Lexit_k2_kernel
    s_cmp_ge_u32 s2, 1024
    s_cbranch_scc1 Lnext_6
    s_load_dwordx2 s[8:9], s[0:1], 96
    v_and_b32 v1, 63, v0
    v_lshrrev_b32 v6, 6, v0
    s_nop 0
    v_readfirstlane_b32 s26, v6
    s_and_b32 s24, s2, 7
    s_lshl_b32 s24, s24, 2
    s_lshr_b32 s25, s2, 8
    s_add_u32 s24, s24, s25
    s_lshr_b32 s25, s2, 3
    s_and_b32 s25, s25, 31
    s_lshl_b32 s25, s25, 2
    s_add_u32 s25, s25, s26
    s_lshl_b32 s25, s25, 4
    s_waitcnt lgkmcnt(0)
    s_mov_b32 s12, s8
    s_mov_b32 s13, s9
    s_mov_b32 s14, 16777216
    s_mov_b32 s15, 0x00020000
    v_and_b32 v2, 15, v1
    v_lshrrev_b32 v3, 4, v1
    v_lshlrev_b32 v6, 5, v2
    v_lshl_add_u32 v6, v3, 3, v6
    v_lshrrev_b32 v7, 2, v2
    v_and_b32 v8, 3, v2
    v_lshl_add_u32 v7, v7, 3, v8
    v_lshlrev_b32 v4, 5, v7
    v_lshl_add_u32 v4, v3, 3, v4
    v_lshlrev_b32 v5, 12, v2
    v_lshl_add_u32 v5, v3, 4, v5
    s_lshl_b32 s27, s24, 11
    s_add_u32 s27, s27, s25
    s_lshl_b32 s27, s27, 5
    buffer_load_dwordx2 v[10:11], v6, s[12:15], s27 offen
    s_sub_i32 s28, 256, s25
    s_max_i32 s28, s28, 0
    s_lshr_b32 s28, s28, 5
    s_add_u32 s29, s27, 2088960
    s_lshl_b32 s30, s24, 16
    s_lshl_b32 s31, s25, 1
    s_add_u32 s30, s30, s31
    s_add_u32 s30, s30, 4193792

    s_cmp_gt_u32 s28, 0
    s_cbranch_scc1 Lsk_7
    s_add_u32 s32, s29, 0
    buffer_load_dwordx2 v[12:13], v4, s[12:15], s32 offen
    buffer_load_dwordx2 v[14:15], v4, s[12:15], s32 offen offset:128
Lsk_7:
    s_cmp_gt_u32 s28, 1
    s_cbranch_scc1 Lsk_9
    s_add_u32 s32, s29, 1024
    buffer_load_dwordx2 v[16:17], v4, s[12:15], s32 offen
    buffer_load_dwordx2 v[18:19], v4, s[12:15], s32 offen offset:128
Lsk_9:
    s_cmp_gt_u32 s28, 2
    s_cbranch_scc1 Lsk_11
    s_add_u32 s32, s29, 2048
    buffer_load_dwordx2 v[20:21], v4, s[12:15], s32 offen
    buffer_load_dwordx2 v[22:23], v4, s[12:15], s32 offen offset:128
Lsk_11:
    s_cmp_gt_u32 s28, 3
    s_cbranch_scc1 Lsk_13
    s_add_u32 s32, s29, 3072
    buffer_load_dwordx2 v[24:25], v4, s[12:15], s32 offen
    buffer_load_dwordx2 v[26:27], v4, s[12:15], s32 offen offset:128
Lsk_13:
    s_cmp_gt_u32 s28, 4
    s_cbranch_scc1 Lsk_15
    s_add_u32 s32, s29, 4096
    buffer_load_dwordx2 v[28:29], v4, s[12:15], s32 offen
    buffer_load_dwordx2 v[30:31], v4, s[12:15], s32 offen offset:128
Lsk_15:
    s_cmp_gt_u32 s28, 5
    s_cbranch_scc1 Lsk_17
    s_add_u32 s32, s29, 5120
    buffer_load_dwordx2 v[32:33], v4, s[12:15], s32 offen
    buffer_load_dwordx2 v[34:35], v4, s[12:15], s32 offen offset:128
Lsk_17:
    s_cmp_gt_u32 s28, 6
    s_cbranch_scc1 Lsk_19
    s_add_u32 s32, s29, 6144
    buffer_load_dwordx2 v[36:37], v4, s[12:15], s32 offen
    buffer_load_dwordx2 v[38:39], v4, s[12:15], s32 offen offset:128
Lsk_19:
    s_cmp_gt_u32 s28, 7
    s_cbranch_scc1 Lsk_21
    s_add_u32 s32, s29, 7168
    buffer_load_dwordx2 v[40:41], v4, s[12:15], s32 offen
    buffer_load_dwordx2 v[42:43], v4, s[12:15], s32 offen offset:128
Lsk_21:
    s_cmp_gt_u32 s28, 8
    s_cbranch_scc1 Lsk_23
    s_add_u32 s32, s29, 8192
    buffer_load_dwordx2 v[44:45], v4, s[12:15], s32 offen
    buffer_load_dwordx2 v[46:47], v4, s[12:15], s32 offen offset:128
Lsk_23:
    s_waitcnt vmcnt(0)
    s_cmp_gt_u32 s28, 0
    s_cbranch_scc1 Lsm_25
    v_mfma_f32_16x16x16_bf16 v[48:51], v[12:13], v[10:11], 0
    v_mfma_f32_16x16x16_bf16 v[52:55], v[14:15], v[10:11], 0
    s_branch Lsn_26
Lsm_25:
    v_mov_b32 v48, 0xce6e6b28
    v_mov_b32 v49, 0xce6e6b28
    v_mov_b32 v50, 0xce6e6b28
    v_mov_b32 v51, 0xce6e6b28
    v_mov_b32 v52, 0xce6e6b28
    v_mov_b32 v53, 0xce6e6b28
    v_mov_b32 v54, 0xce6e6b28
    v_mov_b32 v55, 0xce6e6b28
Lsn_26:
    s_cmp_gt_u32 s28, 1
    s_cbranch_scc1 Lsm_27
    v_mfma_f32_16x16x16_bf16 v[56:59], v[16:17], v[10:11], 0
    v_mfma_f32_16x16x16_bf16 v[60:63], v[18:19], v[10:11], 0
    s_branch Lsn_28
Lsm_27:
    v_mov_b32 v56, 0xce6e6b28
    v_mov_b32 v57, 0xce6e6b28
    v_mov_b32 v58, 0xce6e6b28
    v_mov_b32 v59, 0xce6e6b28
    v_mov_b32 v60, 0xce6e6b28
    v_mov_b32 v61, 0xce6e6b28
    v_mov_b32 v62, 0xce6e6b28
    v_mov_b32 v63, 0xce6e6b28
Lsn_28:
    s_cmp_gt_u32 s28, 2
    s_cbranch_scc1 Lsm_29
    v_mfma_f32_16x16x16_bf16 v[64:67], v[20:21], v[10:11], 0
    v_mfma_f32_16x16x16_bf16 v[68:71], v[22:23], v[10:11], 0
    s_branch Lsn_30
Lsm_29:
    v_mov_b32 v64, 0xce6e6b28
    v_mov_b32 v65, 0xce6e6b28
    v_mov_b32 v66, 0xce6e6b28
    v_mov_b32 v67, 0xce6e6b28
    v_mov_b32 v68, 0xce6e6b28
    v_mov_b32 v69, 0xce6e6b28
    v_mov_b32 v70, 0xce6e6b28
    v_mov_b32 v71, 0xce6e6b28
Lsn_30:
    s_cmp_gt_u32 s28, 3
    s_cbranch_scc1 Lsm_31
    v_mfma_f32_16x16x16_bf16 v[72:75], v[24:25], v[10:11], 0
    v_mfma_f32_16x16x16_bf16 v[76:79], v[26:27], v[10:11], 0
    s_branch Lsn_32
Lsm_31:
    v_mov_b32 v72, 0xce6e6b28
    v_mov_b32 v73, 0xce6e6b28
    v_mov_b32 v74, 0xce6e6b28
    v_mov_b32 v75, 0xce6e6b28
    v_mov_b32 v76, 0xce6e6b28
    v_mov_b32 v77, 0xce6e6b28
    v_mov_b32 v78, 0xce6e6b28
    v_mov_b32 v79, 0xce6e6b28
Lsn_32:
    s_cmp_gt_u32 s28, 4
    s_cbranch_scc1 Lsm_33
    v_mfma_f32_16x16x16_bf16 v[80:83], v[28:29], v[10:11], 0
    v_mfma_f32_16x16x16_bf16 v[84:87], v[30:31], v[10:11], 0
    s_branch Lsn_34
Lsm_33:
    v_mov_b32 v80, 0xce6e6b28
    v_mov_b32 v81, 0xce6e6b28
    v_mov_b32 v82, 0xce6e6b28
    v_mov_b32 v83, 0xce6e6b28
    v_mov_b32 v84, 0xce6e6b28
    v_mov_b32 v85, 0xce6e6b28
    v_mov_b32 v86, 0xce6e6b28
    v_mov_b32 v87, 0xce6e6b28
Lsn_34:
    s_cmp_gt_u32 s28, 5
    s_cbranch_scc1 Lsm_35
    v_mfma_f32_16x16x16_bf16 v[88:91], v[32:33], v[10:11], 0
    v_mfma_f32_16x16x16_bf16 v[92:95], v[34:35], v[10:11], 0
    s_branch Lsn_36
Lsm_35:
    v_mov_b32 v88, 0xce6e6b28
    v_mov_b32 v89, 0xce6e6b28
    v_mov_b32 v90, 0xce6e6b28
    v_mov_b32 v91, 0xce6e6b28
    v_mov_b32 v92, 0xce6e6b28
    v_mov_b32 v93, 0xce6e6b28
    v_mov_b32 v94, 0xce6e6b28
    v_mov_b32 v95, 0xce6e6b28
Lsn_36:
    s_cmp_gt_u32 s28, 6
    s_cbranch_scc1 Lsm_37
    v_mfma_f32_16x16x16_bf16 v[96:99], v[36:37], v[10:11], 0
    v_mfma_f32_16x16x16_bf16 v[100:103], v[38:39], v[10:11], 0
    s_branch Lsn_38
Lsm_37:
    v_mov_b32 v96, 0xce6e6b28
    v_mov_b32 v97, 0xce6e6b28
    v_mov_b32 v98, 0xce6e6b28
    v_mov_b32 v99, 0xce6e6b28
    v_mov_b32 v100, 0xce6e6b28
    v_mov_b32 v101, 0xce6e6b28
    v_mov_b32 v102, 0xce6e6b28
    v_mov_b32 v103, 0xce6e6b28
Lsn_38:
    s_cmp_gt_u32 s28, 7
    s_cbranch_scc1 Lsm_39
    v_mfma_f32_16x16x16_bf16 v[104:107], v[40:41], v[10:11], 0
    v_mfma_f32_16x16x16_bf16 v[108:111], v[42:43], v[10:11], 0
    s_branch Lsn_40
Lsm_39:
    v_mov_b32 v104, 0xce6e6b28
    v_mov_b32 v105, 0xce6e6b28
    v_mov_b32 v106, 0xce6e6b28
    v_mov_b32 v107, 0xce6e6b28
    v_mov_b32 v108, 0xce6e6b28
    v_mov_b32 v109, 0xce6e6b28
    v_mov_b32 v110, 0xce6e6b28
    v_mov_b32 v111, 0xce6e6b28
Lsn_40:
    s_cmp_gt_u32 s28, 8
    s_cbranch_scc1 Lsm_41
    v_mfma_f32_16x16x16_bf16 v[112:115], v[44:45], v[10:11], 0
    v_mfma_f32_16x16x16_bf16 v[116:119], v[46:47], v[10:11], 0
    s_branch Lsn_42
Lsm_41:
    v_mov_b32 v112, 0xce6e6b28
    v_mov_b32 v113, 0xce6e6b28
    v_mov_b32 v114, 0xce6e6b28
    v_mov_b32 v115, 0xce6e6b28
    v_mov_b32 v116, 0xce6e6b28
    v_mov_b32 v117, 0xce6e6b28
    v_mov_b32 v118, 0xce6e6b28
    v_mov_b32 v119, 0xce6e6b28
Lsn_42:
    s_cmp_gt_u32 s28, 0
    s_cbranch_scc1 Lvk_43
    s_add_u32 s33, s30, 0
    buffer_load_dwordx4 v[12:15], v5, s[12:15], s33 offen
    s_branch Lvj_44
Lvk_43:
    v_mov_b32 v12, 0
    v_mov_b32 v13, 0
    v_mov_b32 v14, 0
    v_mov_b32 v15, 0
Lvj_44:
    s_cmp_gt_u32 s28, 1
    s_cbranch_scc1 Lvk_45
    s_add_u32 s33, s30, 64
    buffer_load_dwordx4 v[16:19], v5, s[12:15], s33 offen
    s_branch Lvj_46
Lvk_45:
    v_mov_b32 v16, 0
    v_mov_b32 v17, 0
    v_mov_b32 v18, 0
    v_mov_b32 v19, 0
Lvj_46:
    s_cmp_gt_u32 s28, 2
    s_cbranch_scc1 Lvk_47
    s_add_u32 s33, s30, 128
    buffer_load_dwordx4 v[20:23], v5, s[12:15], s33 offen
    s_branch Lvj_48
Lvk_47:
    v_mov_b32 v20, 0
    v_mov_b32 v21, 0
    v_mov_b32 v22, 0
    v_mov_b32 v23, 0
Lvj_48:
    s_cmp_gt_u32 s28, 3
    s_cbranch_scc1 Lvk_49
    s_add_u32 s33, s30, 192
    buffer_load_dwordx4 v[24:27], v5, s[12:15], s33 offen
    s_branch Lvj_50
Lvk_49:
    v_mov_b32 v24, 0
    v_mov_b32 v25, 0
    v_mov_b32 v26, 0
    v_mov_b32 v27, 0
Lvj_50:
    s_cmp_gt_u32 s28, 4
    s_cbranch_scc1 Lvk_51
    s_add_u32 s33, s30, 256
    buffer_load_dwordx4 v[28:31], v5, s[12:15], s33 offen
    s_branch Lvj_52
Lvk_51:
    v_mov_b32 v28, 0
    v_mov_b32 v29, 0
    v_mov_b32 v30, 0
    v_mov_b32 v31, 0
Lvj_52:
    s_cmp_gt_u32 s28, 5
    s_cbranch_scc1 Lvk_53
    s_add_u32 s33, s30, 320
    buffer_load_dwordx4 v[32:35], v5, s[12:15], s33 offen
    s_branch Lvj_54
Lvk_53:
    v_mov_b32 v32, 0
    v_mov_b32 v33, 0
    v_mov_b32 v34, 0
    v_mov_b32 v35, 0
Lvj_54:
    s_cmp_gt_u32 s28, 6
    s_cbranch_scc1 Lvk_55
    s_add_u32 s33, s30, 384
    buffer_load_dwordx4 v[36:39], v5, s[12:15], s33 offen
    s_branch Lvj_56
Lvk_55:
    v_mov_b32 v36, 0
    v_mov_b32 v37, 0
    v_mov_b32 v38, 0
    v_mov_b32 v39, 0
Lvj_56:
    s_cmp_gt_u32 s28, 7
    s_cbranch_scc1 Lvk_57
    s_add_u32 s33, s30, 448
    buffer_load_dwordx4 v[40:43], v5, s[12:15], s33 offen
    s_branch Lvj_58
Lvk_57:
    v_mov_b32 v40, 0
    v_mov_b32 v41, 0
    v_mov_b32 v42, 0
    v_mov_b32 v43, 0
Lvj_58:
    s_cmp_gt_u32 s28, 8
    s_cbranch_scc1 Lvk_59
    s_add_u32 s33, s30, 512
    buffer_load_dwordx4 v[44:47], v5, s[12:15], s33 offen
    s_branch Lvj_60
Lvk_59:
    v_mov_b32 v44, 0
    v_mov_b32 v45, 0
    v_mov_b32 v46, 0
    v_mov_b32 v47, 0
Lvj_60:
    s_nop 7
    s_nop 1
    v_lshlrev_b32 v6, 3, v3
    v_mov_b32 v7, 0xce6e6b28
    v_add_u32 v8, 0, v6
    v_cmp_lt_u32 vcc, v2, v8
    s_nop 1
    v_cndmask_b32 v48, v7, v48, vcc
    v_cndmask_b32 v112, v112, v7, vcc

    v_add_u32 v8, 1, v6
    v_cmp_lt_u32 vcc, v2, v8
    s_nop 1
    v_cndmask_b32 v49, v7, v49, vcc
    v_cndmask_b32 v113, v113, v7, vcc

    v_add_u32 v8, 2, v6
    v_cmp_lt_u32 vcc, v2, v8
    s_nop 1
    v_cndmask_b32 v50, v7, v50, vcc
    v_cndmask_b32 v114, v114, v7, vcc

    v_add_u32 v8, 3, v6
    v_cmp_lt_u32 vcc, v2, v8
    s_nop 1
    v_cndmask_b32 v51, v7, v51, vcc
    v_cndmask_b32 v115, v115, v7, vcc

    v_add_u32 v8, 4, v6
    v_cmp_lt_u32 vcc, v2, v8
    s_nop 1
    v_cndmask_b32 v52, v7, v52, vcc
    v_cndmask_b32 v116, v116, v7, vcc

    v_add_u32 v8, 5, v6
    v_cmp_lt_u32 vcc, v2, v8
    s_nop 1
    v_cndmask_b32 v53, v7, v53, vcc
    v_cndmask_b32 v117, v117, v7, vcc

    v_add_u32 v8, 6, v6
    v_cmp_lt_u32 vcc, v2, v8
    s_nop 1
    v_cndmask_b32 v54, v7, v54, vcc
    v_cndmask_b32 v118, v118, v7, vcc

    v_add_u32 v8, 7, v6
    v_cmp_lt_u32 vcc, v2, v8
    s_nop 1
    v_cndmask_b32 v55, v7, v55, vcc
    v_cndmask_b32 v119, v119, v7, vcc

    s_cmp_ge_u32 s25, 256
    s_cbranch_scc1 Lfast_61
    s_bitcmp1_b32 s25, 4
    s_cbranch_scc0 Lfast_61
    v_cmp_gt_u32 vcc, 2, v3

    s_cmp_lg_u32 s28, 0
    s_cbranch_scc1 Lnp_62
    v_cndmask_b32 v48, v48, v7, vcc
    v_cndmask_b32 v49, v49, v7, vcc
    v_cndmask_b32 v50, v50, v7, vcc
    v_cndmask_b32 v51, v51, v7, vcc
    v_cndmask_b32 v52, v52, v7, vcc
    v_cndmask_b32 v53, v53, v7, vcc
    v_cndmask_b32 v54, v54, v7, vcc
    v_cndmask_b32 v55, v55, v7, vcc
Lnp_62:
    s_cmp_lg_u32 s28, 1
    s_cbranch_scc1 Lnp_63
    v_cndmask_b32 v56, v56, v7, vcc
    v_cndmask_b32 v57, v57, v7, vcc
    v_cndmask_b32 v58, v58, v7, vcc
    v_cndmask_b32 v59, v59, v7, vcc
    v_cndmask_b32 v60, v60, v7, vcc
    v_cndmask_b32 v61, v61, v7, vcc
    v_cndmask_b32 v62, v62, v7, vcc
    v_cndmask_b32 v63, v63, v7, vcc
Lnp_63:
    s_cmp_lg_u32 s28, 2
    s_cbranch_scc1 Lnp_64
    v_cndmask_b32 v64, v64, v7, vcc
    v_cndmask_b32 v65, v65, v7, vcc
    v_cndmask_b32 v66, v66, v7, vcc
    v_cndmask_b32 v67, v67, v7, vcc
    v_cndmask_b32 v68, v68, v7, vcc
    v_cndmask_b32 v69, v69, v7, vcc
    v_cndmask_b32 v70, v70, v7, vcc
    v_cndmask_b32 v71, v71, v7, vcc
Lnp_64:
    s_cmp_lg_u32 s28, 3
    s_cbranch_scc1 Lnp_65
    v_cndmask_b32 v72, v72, v7, vcc
    v_cndmask_b32 v73, v73, v7, vcc
    v_cndmask_b32 v74, v74, v7, vcc
    v_cndmask_b32 v75, v75, v7, vcc
    v_cndmask_b32 v76, v76, v7, vcc
    v_cndmask_b32 v77, v77, v7, vcc
    v_cndmask_b32 v78, v78, v7, vcc
    v_cndmask_b32 v79, v79, v7, vcc
Lnp_65:
    s_cmp_lg_u32 s28, 4
    s_cbranch_scc1 Lnp_66
    v_cndmask_b32 v80, v80, v7, vcc
    v_cndmask_b32 v81, v81, v7, vcc
    v_cndmask_b32 v82, v82, v7, vcc
    v_cndmask_b32 v83, v83, v7, vcc
    v_cndmask_b32 v84, v84, v7, vcc
    v_cndmask_b32 v85, v85, v7, vcc
    v_cndmask_b32 v86, v86, v7, vcc
    v_cndmask_b32 v87, v87, v7, vcc
Lnp_66:
    s_cmp_lg_u32 s28, 5
    s_cbranch_scc1 Lnp_67
    v_cndmask_b32 v88, v88, v7, vcc
    v_cndmask_b32 v89, v89, v7, vcc
    v_cndmask_b32 v90, v90, v7, vcc
    v_cndmask_b32 v91, v91, v7, vcc
    v_cndmask_b32 v92, v92, v7, vcc
    v_cndmask_b32 v93, v93, v7, vcc
    v_cndmask_b32 v94, v94, v7, vcc
    v_cndmask_b32 v95, v95, v7, vcc
Lnp_67:
    s_cmp_lg_u32 s28, 6
    s_cbranch_scc1 Lnp_68
    v_cndmask_b32 v96, v96, v7, vcc
    v_cndmask_b32 v97, v97, v7, vcc
    v_cndmask_b32 v98, v98, v7, vcc
    v_cndmask_b32 v99, v99, v7, vcc
    v_cndmask_b32 v100, v100, v7, vcc
    v_cndmask_b32 v101, v101, v7, vcc
    v_cndmask_b32 v102, v102, v7, vcc
    v_cndmask_b32 v103, v103, v7, vcc
Lnp_68:
    s_cmp_lg_u32 s28, 7
    s_cbranch_scc1 Lnp_69
    v_cndmask_b32 v104, v104, v7, vcc
    v_cndmask_b32 v105, v105, v7, vcc
    v_cndmask_b32 v106, v106, v7, vcc
    v_cndmask_b32 v107, v107, v7, vcc
    v_cndmask_b32 v108, v108, v7, vcc
    v_cndmask_b32 v109, v109, v7, vcc
    v_cndmask_b32 v110, v110, v7, vcc
    v_cndmask_b32 v111, v111, v7, vcc
Lnp_69:
Lfast_61:
    v_max3_f32 v6, v48, v49, v50
    v_max_f32 v6, v6, v51
    v_max3_f32 v6, v6, v52, v53
    v_max3_f32 v6, v6, v54, v55
    v_max3_f32 v6, v6, v56, v57
    v_max3_f32 v6, v6, v58, v59
    v_max3_f32 v6, v6, v60, v61
    v_max3_f32 v6, v6, v62, v63
    v_max3_f32 v6, v6, v64, v65
    v_max3_f32 v6, v6, v66, v67
    v_max3_f32 v6, v6, v68, v69
    v_max3_f32 v6, v6, v70, v71
    v_max3_f32 v6, v6, v72, v73
    v_max3_f32 v6, v6, v74, v75
    v_max3_f32 v6, v6, v76, v77
    v_max3_f32 v6, v6, v78, v79
    v_max3_f32 v6, v6, v80, v81
    v_max3_f32 v6, v6, v82, v83
    v_max3_f32 v6, v6, v84, v85
    v_max3_f32 v6, v6, v86, v87
    v_max3_f32 v6, v6, v88, v89
    v_max3_f32 v6, v6, v90, v91
    v_max3_f32 v6, v6, v92, v93
    v_max3_f32 v6, v6, v94, v95
    v_max3_f32 v6, v6, v96, v97
    v_max3_f32 v6, v6, v98, v99
    v_max3_f32 v6, v6, v100, v101
    v_max3_f32 v6, v6, v102, v103
    v_max3_f32 v6, v6, v104, v105
    v_max3_f32 v6, v6, v106, v107
    v_max3_f32 v6, v6, v108, v109
    v_max3_f32 v6, v6, v110, v111
    v_max3_f32 v6, v6, v112, v113
    v_max3_f32 v6, v6, v114, v115
    v_max3_f32 v6, v6, v116, v117
    v_max3_f32 v6, v6, v118, v119
    v_mov_b32 v7, v6
    s_nop 1
    v_permlane32_swap_b32 v6, v7
    v_max_f32 v6, v6, v7
    v_mov_b32 v7, v6
    s_nop 1
    v_permlane16_swap_b32 v6, v7
    v_max_f32 v6, v6, v7
    s_mov_b32 s34, 0x3eb8aa3b
    v_mul_f32 v8, s34, v6
    v_sub_f32 v8, 0, v8

    v_fma_f32 v48, v48, s34, v8
    v_exp_f32 v48, v48
    v_fma_f32 v49, v49, s34, v8
    v_exp_f32 v49, v49
    v_fma_f32 v50, v50, s34, v8
    v_exp_f32 v50, v50
    v_fma_f32 v51, v51, s34, v8
    v_exp_f32 v51, v51
    v_fma_f32 v52, v52, s34, v8
    v_exp_f32 v52, v52
    v_fma_f32 v53, v53, s34, v8
    v_exp_f32 v53, v53
    v_fma_f32 v54, v54, s34, v8
    v_exp_f32 v54, v54
    v_fma_f32 v55, v55, s34, v8
    v_exp_f32 v55, v55
    v_fma_f32 v56, v56, s34, v8
    v_exp_f32 v56, v56
    v_fma_f32 v57, v57, s34, v8
    v_exp_f32 v57, v57
    v_fma_f32 v58, v58, s34, v8
    v_exp_f32 v58, v58
    v_fma_f32 v59, v59, s34, v8
    v_exp_f32 v59, v59
    v_fma_f32 v60, v60, s34, v8
    v_exp_f32 v60, v60
    v_fma_f32 v61, v61, s34, v8
    v_exp_f32 v61, v61
    v_fma_f32 v62, v62, s34, v8
    v_exp_f32 v62, v62
    v_fma_f32 v63, v63, s34, v8
    v_exp_f32 v63, v63
    v_fma_f32 v64, v64, s34, v8
    v_exp_f32 v64, v64
    v_fma_f32 v65, v65, s34, v8
    v_exp_f32 v65, v65
    v_fma_f32 v66, v66, s34, v8
    v_exp_f32 v66, v66
    v_fma_f32 v67, v67, s34, v8
    v_exp_f32 v67, v67
    v_fma_f32 v68, v68, s34, v8
    v_exp_f32 v68, v68
    v_fma_f32 v69, v69, s34, v8
    v_exp_f32 v69, v69
    v_fma_f32 v70, v70, s34, v8
    v_exp_f32 v70, v70
    v_fma_f32 v71, v71, s34, v8
    v_exp_f32 v71, v71
    v_fma_f32 v72, v72, s34, v8
    v_exp_f32 v72, v72
    v_fma_f32 v73, v73, s34, v8
    v_exp_f32 v73, v73
    v_fma_f32 v74, v74, s34, v8
    v_exp_f32 v74, v74
    v_fma_f32 v75, v75, s34, v8
    v_exp_f32 v75, v75
    v_fma_f32 v76, v76, s34, v8
    v_exp_f32 v76, v76
    v_fma_f32 v77, v77, s34, v8
    v_exp_f32 v77, v77
    v_fma_f32 v78, v78, s34, v8
    v_exp_f32 v78, v78
    v_fma_f32 v79, v79, s34, v8
    v_exp_f32 v79, v79
    v_fma_f32 v80, v80, s34, v8
    v_exp_f32 v80, v80
    v_fma_f32 v81, v81, s34, v8
    v_exp_f32 v81, v81
    v_fma_f32 v82, v82, s34, v8
    v_exp_f32 v82, v82
    v_fma_f32 v83, v83, s34, v8
    v_exp_f32 v83, v83
    v_fma_f32 v84, v84, s34, v8
    v_exp_f32 v84, v84
    v_fma_f32 v85, v85, s34, v8
    v_exp_f32 v85, v85
    v_fma_f32 v86, v86, s34, v8
    v_exp_f32 v86, v86
    v_fma_f32 v87, v87, s34, v8
    v_exp_f32 v87, v87
    v_fma_f32 v88, v88, s34, v8
    v_exp_f32 v88, v88
    v_fma_f32 v89, v89, s34, v8
    v_exp_f32 v89, v89
    v_fma_f32 v90, v90, s34, v8
    v_exp_f32 v90, v90
    v_fma_f32 v91, v91, s34, v8
    v_exp_f32 v91, v91
    v_fma_f32 v92, v92, s34, v8
    v_exp_f32 v92, v92
    v_fma_f32 v93, v93, s34, v8
    v_exp_f32 v93, v93
    v_fma_f32 v94, v94, s34, v8
    v_exp_f32 v94, v94
    v_fma_f32 v95, v95, s34, v8
    v_exp_f32 v95, v95
    v_fma_f32 v96, v96, s34, v8
    v_exp_f32 v96, v96
    v_fma_f32 v97, v97, s34, v8
    v_exp_f32 v97, v97
    v_fma_f32 v98, v98, s34, v8
    v_exp_f32 v98, v98
    v_fma_f32 v99, v99, s34, v8
    v_exp_f32 v99, v99
    v_fma_f32 v100, v100, s34, v8
    v_exp_f32 v100, v100
    v_fma_f32 v101, v101, s34, v8
    v_exp_f32 v101, v101
    v_fma_f32 v102, v102, s34, v8
    v_exp_f32 v102, v102
    v_fma_f32 v103, v103, s34, v8
    v_exp_f32 v103, v103
    v_fma_f32 v104, v104, s34, v8
    v_exp_f32 v104, v104
    v_fma_f32 v105, v105, s34, v8
    v_exp_f32 v105, v105
    v_fma_f32 v106, v106, s34, v8
    v_exp_f32 v106, v106
    v_fma_f32 v107, v107, s34, v8
    v_exp_f32 v107, v107
    v_fma_f32 v108, v108, s34, v8
    v_exp_f32 v108, v108
    v_fma_f32 v109, v109, s34, v8
    v_exp_f32 v109, v109
    v_fma_f32 v110, v110, s34, v8
    v_exp_f32 v110, v110
    v_fma_f32 v111, v111, s34, v8
    v_exp_f32 v111, v111
    v_fma_f32 v112, v112, s34, v8
    v_exp_f32 v112, v112
    v_fma_f32 v113, v113, s34, v8
    v_exp_f32 v113, v113
    v_fma_f32 v114, v114, s34, v8
    v_exp_f32 v114, v114
    v_fma_f32 v115, v115, s34, v8
    v_exp_f32 v115, v115
    v_fma_f32 v116, v116, s34, v8
    v_exp_f32 v116, v116
    v_fma_f32 v117, v117, s34, v8
    v_exp_f32 v117, v117
    v_fma_f32 v118, v118, s34, v8
    v_exp_f32 v118, v118
    v_fma_f32 v119, v119, s34, v8
    v_exp_f32 v119, v119
    s_nop 0
    v_cvt_pk_bf16_f32 v48, v48, v49
    v_cvt_pk_bf16_f32 v49, v50, v51
    v_cvt_pk_bf16_f32 v50, v52, v53
    v_cvt_pk_bf16_f32 v51, v54, v55
    v_cvt_pk_bf16_f32 v52, v56, v57
    v_cvt_pk_bf16_f32 v53, v58, v59
    v_cvt_pk_bf16_f32 v54, v60, v61
    v_cvt_pk_bf16_f32 v55, v62, v63
    v_cvt_pk_bf16_f32 v56, v64, v65
    v_cvt_pk_bf16_f32 v57, v66, v67
    v_cvt_pk_bf16_f32 v58, v68, v69
    v_cvt_pk_bf16_f32 v59, v70, v71
    v_cvt_pk_bf16_f32 v60, v72, v73
    v_cvt_pk_bf16_f32 v61, v74, v75
    v_cvt_pk_bf16_f32 v62, v76, v77
    v_cvt_pk_bf16_f32 v63, v78, v79
    v_cvt_pk_bf16_f32 v64, v80, v81
    v_cvt_pk_bf16_f32 v65, v82, v83
    v_cvt_pk_bf16_f32 v66, v84, v85
    v_cvt_pk_bf16_f32 v67, v86, v87
    v_cvt_pk_bf16_f32 v68, v88, v89
    v_cvt_pk_bf16_f32 v69, v90, v91
    v_cvt_pk_bf16_f32 v70, v92, v93
    v_cvt_pk_bf16_f32 v71, v94, v95
    v_cvt_pk_bf16_f32 v72, v96, v97
    v_cvt_pk_bf16_f32 v73, v98, v99
    v_cvt_pk_bf16_f32 v74, v100, v101
    v_cvt_pk_bf16_f32 v75, v102, v103
    v_cvt_pk_bf16_f32 v76, v104, v105
    v_cvt_pk_bf16_f32 v77, v106, v107
    v_cvt_pk_bf16_f32 v78, v108, v109
    v_cvt_pk_bf16_f32 v79, v110, v111
    v_cvt_pk_bf16_f32 v80, v112, v113
    v_cvt_pk_bf16_f32 v81, v114, v115
    v_cvt_pk_bf16_f32 v82, v116, v117
    v_cvt_pk_bf16_f32 v83, v118, v119
    v_mov_b32 v88, 0x3f803f80
    v_mov_b32 v89, 0x3f803f80
    v_mov_b32 v90, 0x3f803f80
    v_mov_b32 v91, 0x3f803f80
    s_waitcnt vmcnt(0)
    v_cmp_gt_u32 vcc, 2, v3
    v_mov_b32 v9, 0
    s_nop 0
    v_cndmask_b32 v44, v9, v44, vcc
    v_cndmask_b32 v45, v9, v45, vcc
    v_cndmask_b32 v46, v9, v46, vcc
    v_cndmask_b32 v47, v9, v47, vcc
    s_nop 1
    v_mfma_f32_16x16x32_bf16 v[120:123], v[12:15], v[48:51], 0
    v_mfma_f32_16x16x32_bf16 v[92:95], v[88:91], v[48:51], 0
    v_mfma_f32_16x16x32_bf16 v[120:123], v[16:19], v[52:55], v[120:123]
    v_mfma_f32_16x16x32_bf16 v[92:95], v[88:91], v[52:55], v[92:95]
    v_mfma_f32_16x16x32_bf16 v[120:123], v[20:23], v[56:59], v[120:123]
    v_mfma_f32_16x16x32_bf16 v[92:95], v[88:91], v[56:59], v[92:95]
    v_mfma_f32_16x16x32_bf16 v[120:123], v[24:27], v[60:63], v[120:123]
    v_mfma_f32_16x16x32_bf16 v[92:95], v[88:91], v[60:63], v[92:95]
    v_mfma_f32_16x16x32_bf16 v[120:123], v[28:31], v[64:67], v[120:123]
    v_mfma_f32_16x16x32_bf16 v[92:95], v[88:91], v[64:67], v[92:95]
    v_mfma_f32_16x16x32_bf16 v[120:123], v[32:35], v[68:71], v[120:123]
    v_mfma_f32_16x16x32_bf16 v[92:95], v[88:91], v[68:71], v[92:95]
    v_mfma_f32_16x16x32_bf16 v[120:123], v[36:39], v[72:75], v[120:123]
    v_mfma_f32_16x16x32_bf16 v[92:95], v[88:91], v[72:75], v[92:95]
    v_mfma_f32_16x16x32_bf16 v[120:123], v[40:43], v[76:79], v[120:123]
    v_mfma_f32_16x16x32_bf16 v[92:95], v[88:91], v[76:79], v[92:95]
    v_mfma_f32_16x16x32_bf16 v[120:123], v[44:47], v[80:83], v[120:123]
    v_mfma_f32_16x16x32_bf16 v[92:95], v[88:91], v[80:83], v[92:95]
    s_nop 7
    s_nop 1
    v_rcp_f32 v6, v92
    s_nop 0
    v_mul_f32 v120, v120, v6
    v_mul_f32 v121, v121, v6
    v_mul_f32 v122, v122, v6
    v_mul_f32 v123, v123, v6
    v_cvt_pk_bf16_f32 v120, v120, v121
    v_cvt_pk_bf16_f32 v121, v122, v123
    v_lshlrev_b32 v4, 10, v2
    v_lshl_add_u32 v4, v3, 3, v4
    s_lshl_b32 s32, s25, 10
    s_lshl_b32 s33, s24, 5
    s_add_u32 s32, s32, s33
    s_add_u32 s32, s32, 6291456
    buffer_store_dwordx2 v[120:121], v4, s[12:15], s32 offen

    s_endpgm
Lnext_6:
    s_sub_u32 s2, s2, 1024
    s_load_dwordx2 s[4:5], s[0:1], 8
    s_load_dwordx2 s[6:7], s[0:1], 16
    s_load_dwordx2 s[8:9], s[0:1], 24
    s_load_dwordx2 s[10:11], s[0:1], 32
    s_load_dwordx2 s[58:59], s[0:1], 40
    s_load_dwordx2 s[60:61], s[0:1], 96
    v_and_b32 v1, 63, v0
    v_lshrrev_b32 v2, 6, v0
    s_nop 0
    v_readfirstlane_b32 s62, v2
    s_mov_b32 s63, s2
    s_waitcnt lgkmcnt(0)
    s_and_b32 s64, s63, 0xffe
    s_lshl_b32 s64, s64, 1
    s_add_u32 s58, s58, s64
    s_addc_u32 s59, s59, 0
    s_load_dword s52, s[58:59], 0
    s_mov_b32 s67, 0
    s_and_b32 s72, s63, 1
    s_mov_b32 s12, s4
    s_mov_b32 s13, s5
    s_mov_b32 s14, 2097152
    s_mov_b32 s15, 0x00020000
    s_mov_b32 s16, s6
    s_mov_b32 s17, s7
    s_mov_b32 s18, 2097152
    s_mov_b32 s19, 0x00020000
    s_mov_b32 s20, s10
    s_mov_b32 s21, s11
    s_mov_b32 s22, 2097152
    s_mov_b32 s23, 0x00020000
    s_mov_b32 s24, s60
    s_mov_b32 s25, s61
    s_mov_b32 s26, 16777216
    s_mov_b32 s27, 0x00020000
    v_lshlrev_b32 v2, 13, v0
    s_lshl_b32 s64, s63, 1
    v_add_u32 v2, s64, v2
    v_add_u32 v3, 4096, v2
    v_subrev_u32 v4, 3072, v2
    s_add_u32 s64, s63, s67
    s_lshl_b32 s65, s64, 12
    v_lshlrev_b32 v5, 6, v1
    v_subrev_u32 v6, 8, v5
    v_add_u32 v6, s65, v6
    buffer_load_dwordx2 v[84:85], v6, s[20:23], 0 offen

    buffer_load_dwordx4 v[86:89], v5, s[20:23], s65 offen offset:0
    buffer_load_dwordx4 v[90:93], v5, s[20:23], s65 offen offset:16
    buffer_load_dwordx4 v[94:97], v5, s[20:23], s65 offen offset:32
    buffer_load_dwordx4 v[98:101], v5, s[20:23], s65 offen offset:48
    v_lshlrev_b32 v7, 4, v0
    s_add_u32 s71, s65, 12582912
    buffer_load_dwordx4 v[76:79], v7, s[24:27], s71 offen

    s_mul_i32 s66, s67, 26800
    v_mov_b32 v72, 0
    v_mov_b32 v73, 0
    v_mov_b32 v74, 0
    v_mov_b32 v75, 0
    v_mul_u32_u24 v7, 80, v1
    v_add_u32 v7, s66, v7

    ds_write_b128 v7, v[72:75] offset:0
    ds_write_b128 v7, v[72:75] offset:16
    ds_write_b128 v7, v[72:75] offset:32
    ds_write_b128 v7, v[72:75] offset:48
    ds_write_b128 v7, v[72:75] offset:64
    v_and_b32 v8, 3, v1
    v_lshlrev_b32 v8, 4, v8
    v_add_u32 v8, s66, v8

    ds_write_b128 v8, v[72:75] offset:14256
    ds_write_b128 v8, v[72:75] offset:18416
    ds_write_b128 v8, v[72:75] offset:22576
    ds_write_b128 v8, v[72:75] offset:26736
    s_waitcnt lgkmcnt(0)
    s_barrier
    s_lshl_b32 s54, s52, 16
    s_and_b32 s55, s52, 0xffff0000
    s_cmp_eq_u32 s72, 1
    s_cselect_b32 s54, s55, s54
    s_waitcnt vmcnt(0)
    v_cmp_eq_u32 vcc, 0, v1
    s_nop 1

    v_mov_b32 v9, 0
    v_cndmask_b32 v84, v84, v9, vcc
    v_cndmask_b32 v85, v85, v9, vcc
    v_alignbit_b32 v32, v101, v101, 16
    v_alignbit_b32 v33, v100, v100, 16
    v_alignbit_b32 v34, v99, v99, 16
    v_alignbit_b32 v35, v98, v98, 16
    v_alignbit_b32 v36, v97, v97, 16
    v_alignbit_b32 v37, v96, v96, 16
    v_alignbit_b32 v38, v95, v95, 16
    v_alignbit_b32 v39, v94, v94, 16
    v_alignbit_b32 v40, v93, v93, 16
    v_alignbit_b32 v41, v92, v92, 16
    v_alignbit_b32 v42, v91, v91, 16
    v_alignbit_b32 v43, v90, v90, 16
    v_alignbit_b32 v44, v89, v89, 16
    v_alignbit_b32 v45, v88, v88, 16
    v_alignbit_b32 v46, v87, v87, 16
    v_alignbit_b32 v47, v86, v86, 16
    v_alignbit_b32 v48, v85, v85, 16
    v_alignbit_b32 v49, v84, v84, 16
    v_lshlrev_b32 v6, 6, v1
    v_sub_u32 v6, 4032, v6

    s_cmp_lg_u32 s62, 0
    s_cbranch_scc1 Lhp_72
    v_mov_b32 v104, v32
    v_mov_b32 v105, v33
    v_mov_b32 v106, v34
    v_mov_b32 v107, v35
    v_mov_b32 v108, v36
    v_mov_b32 v109, v37
    v_mov_b32 v110, v38
    v_mov_b32 v111, v39
    v_mov_b32 v112, v40
    v_mov_b32 v113, v41
    v_mov_b32 v114, v42
    v_mov_b32 v115, v43
    v_mov_b32 v116, v44
    v_mov_b32 v117, v45
    v_mov_b32 v118, v46
    v_mov_b32 v119, v47
    ds_write_b128 v6, v[104:107] offset:10160
    ds_write_b128 v6, v[108:111] offset:10176
    ds_write_b128 v6, v[112:115] offset:10192
    ds_write_b128 v6, v[116:119] offset:10208
    s_branch Lhd_71
Lhp_72:
    s_cmp_lg_u32 s62, 1
    s_cbranch_scc1 Lhp_73
    v_alignbit_b32 v104, v33, v32, 16
    v_alignbit_b32 v105, v34, v33, 16
    v_alignbit_b32 v106, v35, v34, 16
    v_alignbit_b32 v107, v36, v35, 16
    v_alignbit_b32 v108, v37, v36, 16
    v_alignbit_b32 v109, v38, v37, 16
    v_alignbit_b32 v110, v39, v38, 16
    v_alignbit_b32 v111, v40, v39, 16
    v_alignbit_b32 v112, v41, v40, 16
    v_alignbit_b32 v113, v42, v41, 16
    v_alignbit_b32 v114, v43, v42, 16
    v_alignbit_b32 v115, v44, v43, 16
    v_alignbit_b32 v116, v45, v44, 16
    v_alignbit_b32 v117, v46, v45, 16
    v_alignbit_b32 v118, v47, v46, 16
    v_alignbit_b32 v119, v48, v47, 16
    ds_write_b128 v6, v[104:107] offset:14320
    ds_write_b128 v6, v[108:111] offset:14336
    ds_write_b128 v6, v[112:115] offset:14352
    ds_write_b128 v6, v[116:119] offset:14368
    s_branch Lhd_71
Lhp_73:
    s_cmp_lg_u32 s62, 2
    s_cbranch_scc1 Lhp_74
    v_mov_b32 v104, v33
    v_mov_b32 v105, v34
    v_mov_b32 v106, v35
    v_mov_b32 v107, v36
    v_mov_b32 v108, v37
    v_mov_b32 v109, v38
    v_mov_b32 v110, v39
    v_mov_b32 v111, v40
    v_mov_b32 v112, v41
    v_mov_b32 v113, v42
    v_mov_b32 v114, v43
    v_mov_b32 v115, v44
    v_mov_b32 v116, v45
    v_mov_b32 v117, v46
    v_mov_b32 v118, v47
    v_mov_b32 v119, v48
    ds_write_b128 v6, v[104:107] offset:18480
    ds_write_b128 v6, v[108:111] offset:18496
    ds_write_b128 v6, v[112:115] offset:18512
    ds_write_b128 v6, v[116:119] offset:18528
    s_branch Lhd_71
Lhp_74:
    s_cmp_lg_u32 s62, 3
    s_cbranch_scc1 Lhp_75
    v_alignbit_b32 v104, v34, v33, 16
    v_alignbit_b32 v105, v35, v34, 16
    v_alignbit_b32 v106, v36, v35, 16
    v_alignbit_b32 v107, v37, v36, 16
    v_alignbit_b32 v108, v38, v37, 16
    v_alignbit_b32 v109, v39, v38, 16
    v_alignbit_b32 v110, v40, v39, 16
    v_alignbit_b32 v111, v41, v40, 16
    v_alignbit_b32 v112, v42, v41, 16
    v_alignbit_b32 v113, v43, v42, 16
    v_alignbit_b32 v114, v44, v43, 16
    v_alignbit_b32 v115, v45, v44, 16
    v_alignbit_b32 v116, v46, v45, 16
    v_alignbit_b32 v117, v47, v46, 16
    v_alignbit_b32 v118, v48, v47, 16
    v_alignbit_b32 v119, v49, v48, 16
    ds_write_b128 v6, v[104:107] offset:22640
    ds_write_b128 v6, v[108:111] offset:22656
    ds_write_b128 v6, v[112:115] offset:22672
    ds_write_b128 v6, v[116:119] offset:22688
    s_branch Lhd_71
Lhp_75:
Lhd_71:
    s_waitcnt lgkmcnt(0)
    v_lshrrev_b32 v3, 2, v0
    v_mul_u32_u24 v3, 80, v3
    v_and_b32 v2, 3, v0
    v_lshl_add_u32 v2, v2, 4, v3
    ds_write_b128 v2, v[76:79] offset:5040
    s_waitcnt lgkmcnt(0)
    s_barrier

    v_and_b32 v5, 31, v1
    v_lshrrev_b32 v6, 5, v1
    v_sub_u32 v2, 31, v5
    v_and_b32 v7, 3, v2
    v_sub_u32 v2, v2, v7
    v_lshlrev_b32 v2, 1, v2
    v_lshl_add_u32 v2, v6, 4, v2
    v_mul_u32_u24 v7, 4160, v7
    v_add3_u32 v2, v2, v7, s66
    v_mul_u32_u24 v3, 80, v5
    v_lshl_add_u32 v3, v6, 4, v3
    v_add_u32 v3, s66, v3

    v_mov_b32 v64, 0
    v_mov_b32 v65, 0
    v_mov_b32 v66, 0
    v_mov_b32 v67, 0
    v_mov_b32 v68, 0
    v_mov_b32 v69, 0
    v_mov_b32 v70, 0
    v_mov_b32 v71, 0
    v_mov_b32 v72, 0
    v_mov_b32 v73, 0
    v_mov_b32 v74, 0
    v_mov_b32 v75, 0
    v_mov_b32 v76, 0
    v_mov_b32 v77, 0
    v_mov_b32 v78, 0
    v_mov_b32 v79, 0
    v_mov_b32 v80, 0
    v_mov_b32 v81, 0
    v_mov_b32 v82, 0
    v_mov_b32 v83, 0
    v_mov_b32 v84, 0
    v_mov_b32 v85, 0
    v_mov_b32 v86, 0
    v_mov_b32 v87, 0
    v_mov_b32 v88, 0
    v_mov_b32 v89, 0
    v_mov_b32 v90, 0
    v_mov_b32 v91, 0
    v_mov_b32 v92, 0
    v_mov_b32 v93, 0
    v_mov_b32 v94, 0
    v_mov_b32 v95, 0
    v_lshlrev_b32 v7, 4, v1
    s_cmp_lg_u32 s62, 0
    s_cbranch_scc1 Lcw_78
    ds_read_b64 v[10:11], v2 offset:14192
    ds_read_b64 v[12:13], v2 offset:14200
    ds_read_b64 v[14:15], v2 offset:14224
    ds_read_b64 v[16:17], v2 offset:14232
    ds_read_b128 v[26:29], v3 offset:5040
    ds_read_b128 v[30:33], v3 offset:5072
    ds_read_b64 v[18:19], v2 offset:14128
    ds_read_b64 v[20:21], v2 offset:14136
    ds_read_b64 v[22:23], v2 offset:14160
    ds_read_b64 v[24:25], v2 offset:14168
    ds_read_b128 v[34:37], v3 offset:4960
    ds_read_b128 v[38:41], v3 offset:4992
    s_waitcnt lgkmcnt(6)
    v_mfma_f32_32x32x16_bf16 v[64:79], v[10:13], v[26:29], v[64:79]
    v_mfma_f32_32x32x16_bf16 v[64:79], v[14:17], v[30:33], v[64:79]
    ds_read_b64 v[10:11], v2 offset:14064
    ds_read_b64 v[12:13], v2 offset:14072
    ds_read_b64 v[14:15], v2 offset:14096
    ds_read_b64 v[16:17], v2 offset:14104
    ds_read_b128 v[26:29], v3 offset:4880
    ds_read_b128 v[30:33], v3 offset:4912
    s_waitcnt lgkmcnt(6)
    v_mfma_f32_32x32x16_bf16 v[64:79], v[18:21], v[34:37], v[64:79]
    v_mfma_f32_32x32x16_bf16 v[64:79], v[22:25], v[38:41], v[64:79]
    ds_read_b64 v[18:19], v2 offset:14000
    ds_read_b64 v[20:21], v2 offset:14008
    ds_read_b64 v[22:23], v2 offset:14032
    ds_read_b64 v[24:25], v2 offset:14040
    ds_read_b128 v[34:37], v3 offset:4800
    ds_read_b128 v[38:41], v3 offset:4832
    s_waitcnt lgkmcnt(6)
    v_mfma_f32_32x32x16_bf16 v[64:79], v[10:13], v[26:29], v[64:79]
    v_mfma_f32_32x32x16_bf16 v[64:79], v[14:17], v[30:33], v[64:79]
    ds_read_b64 v[10:11], v2 offset:13936
    ds_read_b64 v[12:13], v2 offset:13944
    ds_read_b64 v[14:15], v2 offset:13968
    ds_read_b64 v[16:17], v2 offset:13976
    ds_read_b128 v[26:29], v3 offset:4720
    ds_read_b128 v[30:33], v3 offset:4752
    s_waitcnt lgkmcnt(6)
    v_mfma_f32_32x32x16_bf16 v[64:79], v[18:21], v[34:37], v[64:79]
    v_mfma_f32_32x32x16_bf16 v[64:79], v[22:25], v[38:41], v[64:79]
    ds_read_b64 v[18:19], v2 offset:13872
    ds_read_b64 v[20:21], v2 offset:13880
    ds_read_b64 v[22:23], v2 offset:13904
    ds_read_b64 v[24:25], v2 offset:13912
    ds_read_b128 v[34:37], v3 offset:4640
    ds_read_b128 v[38:41], v3 offset:4672
    s_waitcnt lgkmcnt(6)
    v_mfma_f32_32x32x16_bf16 v[64:79], v[10:13], v[26:29], v[64:79]
    v_mfma_f32_32x32x16_bf16 v[64:79], v[14:17], v[30:33], v[64:79]
    ds_read_b64 v[10:11], v2 offset:13808
    ds_read_b64 v[12:13], v2 offset:13816
    ds_read_b64 v[14:15], v2 offset:13840
    ds_read_b64 v[16:17], v2 offset:13848
    ds_read_b128 v[26:29], v3 offset:4560
    ds_read_b128 v[30:33], v3 offset:4592
    s_waitcnt lgkmcnt(6)
    v_mfma_f32_32x32x16_bf16 v[64:79], v[18:21], v[34:37], v[64:79]
    v_mfma_f32_32x32x16_bf16 v[64:79], v[22:25], v[38:41], v[64:79]
    ds_read_b64 v[18:19], v2 offset:13744
    ds_read_b64 v[20:21], v2 offset:13752
    ds_read_b64 v[22:23], v2 offset:13776
    ds_read_b64 v[24:25], v2 offset:13784
    ds_read_b128 v[34:37], v3 offset:4480
    ds_read_b128 v[38:41], v3 offset:4512
    s_waitcnt lgkmcnt(6)
    v_mfma_f32_32x32x16_bf16 v[64:79], v[10:13], v[26:29], v[64:79]
    v_mfma_f32_32x32x16_bf16 v[64:79], v[14:17], v[30:33], v[64:79]
    ds_read_b64 v[10:11], v2 offset:13680
    ds_read_b64 v[12:13], v2 offset:13688
    ds_read_b64 v[14:15], v2 offset:13712
    ds_read_b64 v[16:17], v2 offset:13720
    ds_read_b128 v[26:29], v3 offset:4400
    ds_read_b128 v[30:33], v3 offset:4432
    s_waitcnt lgkmcnt(6)
    v_mfma_f32_32x32x16_bf16 v[64:79], v[18:21], v[34:37], v[64:79]
    v_mfma_f32_32x32x16_bf16 v[64:79], v[22:25], v[38:41], v[64:79]
    ds_read_b64 v[18:19], v2 offset:13616
    ds_read_b64 v[20:21], v2 offset:13624
    ds_read_b64 v[22:23], v2 offset:13648
    ds_read_b64 v[24:25], v2 offset:13656
    ds_read_b128 v[34:37], v3 offset:4320
    ds_read_b128 v[38:41], v3 offset:4352
    s_waitcnt lgkmcnt(6)
    v_mfma_f32_32x32x16_bf16 v[64:79], v[10:13], v[26:29], v[64:79]
    v_mfma_f32_32x32x16_bf16 v[64:79], v[14:17], v[30:33], v[64:79]
    ds_read_b64 v[10:11], v2 offset:13552
    ds_read_b64 v[12:13], v2 offset:13560
    ds_read_b64 v[14:15], v2 offset:13584
    ds_read_b64 v[16:17], v2 offset:13592
    ds_read_b128 v[26:29], v3 offset:4240
    ds_read_b128 v[30:33], v3 offset:4272
    s_waitcnt lgkmcnt(6)
    v_mfma_f32_32x32x16_bf16 v[64:79], v[18:21], v[34:37], v[64:79]
    v_mfma_f32_32x32x16_bf16 v[64:79], v[22:25], v[38:41], v[64:79]
    ds_read_b64 v[18:19], v2 offset:13488
    ds_read_b64 v[20:21], v2 offset:13496
    ds_read_b64 v[22:23], v2 offset:13520
    ds_read_b64 v[24:25], v2 offset:13528
    ds_read_b128 v[34:37], v3 offset:4160
    ds_read_b128 v[38:41], v3 offset:4192
    s_waitcnt lgkmcnt(6)
    v_mfma_f32_32x32x16_bf16 v[64:79], v[10:13], v[26:29], v[64:79]
    v_mfma_f32_32x32x16_bf16 v[64:79], v[14:17], v[30:33], v[64:79]
    ds_read_b64 v[10:11], v2 offset:13424
    ds_read_b64 v[12:13], v2 offset:13432
    ds_read_b64 v[14:15], v2 offset:13456
    ds_read_b64 v[16:17], v2 offset:13464
    ds_read_b128 v[26:29], v3 offset:4080
    ds_read_b128 v[30:33], v3 offset:4112
    s_waitcnt lgkmcnt(6)
    v_mfma_f32_32x32x16_bf16 v[64:79], v[18:21], v[34:37], v[64:79]
    v_mfma_f32_32x32x16_bf16 v[64:79], v[22:25], v[38:41], v[64:79]
    ds_read_b64 v[18:19], v2 offset:13360
    ds_read_b64 v[20:21], v2 offset:13368
    ds_read_b64 v[22:23], v2 offset:13392
    ds_read_b64 v[24:25], v2 offset:13400
    ds_read_b128 v[34:37], v3 offset:4000
    ds_read_b128 v[38:41], v3 offset:4032
    s_waitcnt lgkmcnt(6)
    v_mfma_f32_32x32x16_bf16 v[64:79], v[10:13], v[26:29], v[64:79]
    v_mfma_f32_32x32x16_bf16 v[64:79], v[14:17], v[30:33], v[64:79]
    ds_read_b64 v[10:11], v2 offset:13296
    ds_read_b64 v[12:13], v2 offset:13304
    ds_read_b64 v[14:15], v2 offset:13328
    ds_read_b64 v[16:17], v2 offset:13336
    ds_read_b128 v[26:29], v3 offset:3920
    ds_read_b128 v[30:33], v3 offset:3952
    s_waitcnt lgkmcnt(6)
    v_mfma_f32_32x32x16_bf16 v[64:79], v[18:21], v[34:37], v[64:79]
    v_mfma_f32_32x32x16_bf16 v[64:79], v[22:25], v[38:41], v[64:79]
    ds_read_b64 v[18:19], v2 offset:13232
    ds_read_b64 v[20:21], v2 offset:13240
    ds_read_b64 v[22:23], v2 offset:13264
    ds_read_b64 v[24:25], v2 offset:13272
    ds_read_b128 v[34:37], v3 offset:3840
    ds_read_b128 v[38:41], v3 offset:3872
    s_waitcnt lgkmcnt(6)
    v_mfma_f32_32x32x16_bf16 v[64:79], v[10:13], v[26:29], v[64:79]
    v_mfma_f32_32x32x16_bf16 v[64:79], v[14:17], v[30:33], v[64:79]
    ds_read_b64 v[10:11], v2 offset:13168
    ds_read_b64 v[12:13], v2 offset:13176
    ds_read_b64 v[14:15], v2 offset:13200
    ds_read_b64 v[16:17], v2 offset:13208
    ds_read_b128 v[26:29], v3 offset:3760
    ds_read_b128 v[30:33], v3 offset:3792
    s_waitcnt lgkmcnt(6)
    v_mfma_f32_32x32x16_bf16 v[64:79], v[18:21], v[34:37], v[64:79]
    v_mfma_f32_32x32x16_bf16 v[64:79], v[22:25], v[38:41], v[64:79]
    ds_read_b64 v[18:19], v2 offset:13104
    ds_read_b64 v[20:21], v2 offset:13112
    ds_read_b64 v[22:23], v2 offset:13136
    ds_read_b64 v[24:25], v2 offset:13144
    ds_read_b128 v[34:37], v3 offset:3680
    ds_read_b128 v[38:41], v3 offset:3712
    s_waitcnt lgkmcnt(6)
    v_mfma_f32_32x32x16_bf16 v[64:79], v[10:13], v[26:29], v[64:79]
    v_mfma_f32_32x32x16_bf16 v[64:79], v[14:17], v[30:33], v[64:79]
    ds_read_b64 v[10:11], v2 offset:13040
    ds_read_b64 v[12:13], v2 offset:13048
    ds_read_b64 v[14:15], v2 offset:13072
    ds_read_b64 v[16:17], v2 offset:13080
    ds_read_b128 v[26:29], v3 offset:3600
    ds_read_b128 v[30:33], v3 offset:3632
    s_waitcnt lgkmcnt(6)
    v_mfma_f32_32x32x16_bf16 v[64:79], v[18:21], v[34:37], v[64:79]
    v_mfma_f32_32x32x16_bf16 v[64:79], v[22:25], v[38:41], v[64:79]
    ds_read_b64 v[18:19], v2 offset:12976
    ds_read_b64 v[20:21], v2 offset:12984
    ds_read_b64 v[22:23], v2 offset:13008
    ds_read_b64 v[24:25], v2 offset:13016
    ds_read_b128 v[34:37], v3 offset:3520
    ds_read_b128 v[38:41], v3 offset:3552
    s_waitcnt lgkmcnt(6)
    v_mfma_f32_32x32x16_bf16 v[64:79], v[10:13], v[26:29], v[64:79]
    v_mfma_f32_32x32x16_bf16 v[64:79], v[14:17], v[30:33], v[64:79]
    ds_read_b64 v[10:11], v2 offset:12912
    ds_read_b64 v[12:13], v2 offset:12920
    ds_read_b64 v[14:15], v2 offset:12944
    ds_read_b64 v[16:17], v2 offset:12952
    ds_read_b128 v[26:29], v3 offset:3440
    ds_read_b128 v[30:33], v3 offset:3472
    s_waitcnt lgkmcnt(6)
    v_mfma_f32_32x32x16_bf16 v[64:79], v[18:21], v[34:37], v[64:79]
    v_mfma_f32_32x32x16_bf16 v[64:79], v[22:25], v[38:41], v[64:79]
    ds_read_b64 v[18:19], v2 offset:12848
    ds_read_b64 v[20:21], v2 offset:12856
    ds_read_b64 v[22:23], v2 offset:12880
    ds_read_b64 v[24:25], v2 offset:12888
    ds_read_b128 v[34:37], v3 offset:3360
    ds_read_b128 v[38:41], v3 offset:3392
    s_waitcnt lgkmcnt(6)
    v_mfma_f32_32x32x16_bf16 v[64:79], v[10:13], v[26:29], v[64:79]
    v_mfma_f32_32x32x16_bf16 v[64:79], v[14:17], v[30:33], v[64:79]
    ds_read_b64 v[10:11], v2 offset:12784
    ds_read_b64 v[12:13], v2 offset:12792
    ds_read_b64 v[14:15], v2 offset:12816
    ds_read_b64 v[16:17], v2 offset:12824
    ds_read_b128 v[26:29], v3 offset:3280
    ds_read_b128 v[30:33], v3 offset:3312
    s_waitcnt lgkmcnt(6)
    v_mfma_f32_32x32x16_bf16 v[64:79], v[18:21], v[34:37], v[64:79]
    v_mfma_f32_32x32x16_bf16 v[64:79], v[22:25], v[38:41], v[64:79]
    ds_read_b64 v[18:19], v2 offset:12720
    ds_read_b64 v[20:21], v2 offset:12728
    ds_read_b64 v[22:23], v2 offset:12752
    ds_read_b64 v[24:25], v2 offset:12760
    ds_read_b128 v[34:37], v3 offset:3200
    ds_read_b128 v[38:41], v3 offset:3232
    s_waitcnt lgkmcnt(6)
    v_mfma_f32_32x32x16_bf16 v[64:79], v[10:13], v[26:29], v[64:79]
    v_mfma_f32_32x32x16_bf16 v[64:79], v[14:17], v[30:33], v[64:79]
    s_waitcnt lgkmcnt(0)
    v_mfma_f32_32x32x16_bf16 v[64:79], v[18:21], v[34:37], v[64:79]
    v_mfma_f32_32x32x16_bf16 v[64:79], v[22:25], v[38:41], v[64:79]
    s_nop 7
    s_nop 7
    s_barrier
    s_waitcnt lgkmcnt(0)
    s_barrier
    ds_read_b128 v[80:83], v7 offset:10160
    ds_read_b128 v[84:87], v7 offset:11184
    ds_read_b128 v[88:91], v7 offset:12208
    ds_read_b128 v[92:95], v7 offset:13232
    s_waitcnt lgkmcnt(0)
    v_add_f32 v64, v64, v80
    v_add_f32 v65, v65, v81
    v_add_f32 v66, v66, v82
    v_add_f32 v67, v67, v83
    v_add_f32 v68, v68, v84
    v_add_f32 v69, v69, v85
    v_add_f32 v70, v70, v86
    v_add_f32 v71, v71, v87
    v_add_f32 v72, v72, v88
    v_add_f32 v73, v73, v89
    v_add_f32 v74, v74, v90
    v_add_f32 v75, v75, v91
    v_add_f32 v76, v76, v92
    v_add_f32 v77, v77, v93
    v_add_f32 v78, v78, v94
    v_add_f32 v79, v79, v95
    s_mov_b32 s69, 0
    s_branch Lc2_76
Lcw_78:
    s_cmp_lg_u32 s62, 1
    s_cbranch_scc1 Lcw_79
    ds_read_b64 v[10:11], v2 offset:12656
    ds_read_b64 v[12:13], v2 offset:12664
    ds_read_b64 v[14:15], v2 offset:12688
    ds_read_b64 v[16:17], v2 offset:12696
    ds_read_b128 v[26:29], v3 offset:3120
    ds_read_b128 v[30:33], v3 offset:3152
    ds_read_b64 v[18:19], v2 offset:12592
    ds_read_b64 v[20:21], v2 offset:12600
    ds_read_b64 v[22:23], v2 offset:12624
    ds_read_b64 v[24:25], v2 offset:12632
    ds_read_b128 v[34:37], v3 offset:3040
    ds_read_b128 v[38:41], v3 offset:3072
    s_waitcnt lgkmcnt(6)
    v_mfma_f32_32x32x16_bf16 v[64:79], v[10:13], v[26:29], v[64:79]
    v_mfma_f32_32x32x16_bf16 v[64:79], v[14:17], v[30:33], v[64:79]
    ds_read_b64 v[10:11], v2 offset:12528
    ds_read_b64 v[12:13], v2 offset:12536
    ds_read_b64 v[14:15], v2 offset:12560
    ds_read_b64 v[16:17], v2 offset:12568
    ds_read_b128 v[26:29], v3 offset:2960
    ds_read_b128 v[30:33], v3 offset:2992
    s_waitcnt lgkmcnt(6)
    v_mfma_f32_32x32x16_bf16 v[64:79], v[18:21], v[34:37], v[64:79]
    v_mfma_f32_32x32x16_bf16 v[64:79], v[22:25], v[38:41], v[64:79]
    ds_read_b64 v[18:19], v2 offset:12464
    ds_read_b64 v[20:21], v2 offset:12472
    ds_read_b64 v[22:23], v2 offset:12496
    ds_read_b64 v[24:25], v2 offset:12504
    ds_read_b128 v[34:37], v3 offset:2880
    ds_read_b128 v[38:41], v3 offset:2912
    s_waitcnt lgkmcnt(6)
    v_mfma_f32_32x32x16_bf16 v[64:79], v[10:13], v[26:29], v[64:79]
    v_mfma_f32_32x32x16_bf16 v[64:79], v[14:17], v[30:33], v[64:79]
    ds_read_b64 v[10:11], v2 offset:12400
    ds_read_b64 v[12:13], v2 offset:12408
    ds_read_b64 v[14:15], v2 offset:12432
    ds_read_b64 v[16:17], v2 offset:12440
    ds_read_b128 v[26:29], v3 offset:2800
    ds_read_b128 v[30:33], v3 offset:2832
    s_waitcnt lgkmcnt(6)
    v_mfma_f32_32x32x16_bf16 v[64:79], v[18:21], v[34:37], v[64:79]
    v_mfma_f32_32x32x16_bf16 v[64:79], v[22:25], v[38:41], v[64:79]
    ds_read_b64 v[18:19], v2 offset:12336
    ds_read_b64 v[20:21], v2 offset:12344
    ds_read_b64 v[22:23], v2 offset:12368
    ds_read_b64 v[24:25], v2 offset:12376
    ds_read_b128 v[34:37], v3 offset:2720
    ds_read_b128 v[38:41], v3 offset:2752
    s_waitcnt lgkmcnt(6)
    v_mfma_f32_32x32x16_bf16 v[64:79], v[10:13], v[26:29], v[64:79]
    v_mfma_f32_32x32x16_bf16 v[64:79], v[14:17], v[30:33], v[64:79]
    ds_read_b64 v[10:11], v2 offset:12272
    ds_read_b64 v[12:13], v2 offset:12280
    ds_read_b64 v[14:15], v2 offset:12304
    ds_read_b64 v[16:17], v2 offset:12312
    ds_read_b128 v[26:29], v3 offset:2640
    ds_read_b128 v[30:33], v3 offset:2672
    s_waitcnt lgkmcnt(6)
    v_mfma_f32_32x32x16_bf16 v[64:79], v[18:21], v[34:37], v[64:79]
    v_mfma_f32_32x32x16_bf16 v[64:79], v[22:25], v[38:41], v[64:79]
    ds_read_b64 v[18:19], v2 offset:12208
    ds_read_b64 v[20:21], v2 offset:12216
    ds_read_b64 v[22:23], v2 offset:12240
    ds_read_b64 v[24:25], v2 offset:12248
    ds_read_b128 v[34:37], v3 offset:2560
    ds_read_b128 v[38:41], v3 offset:2592
    s_waitcnt lgkmcnt(6)
    v_mfma_f32_32x32x16_bf16 v[64:79], v[10:13], v[26:29], v[64:79]
    v_mfma_f32_32x32x16_bf16 v[64:79], v[14:17], v[30:33], v[64:79]
    ds_read_b64 v[10:11], v2 offset:14192
    ds_read_b64 v[12:13], v2 offset:14200
    ds_read_b64 v[14:15], v2 offset:14224
    ds_read_b64 v[16:17], v2 offset:14232
    ds_read_b128 v[26:29], v3 offset:7600
    ds_read_b128 v[30:33], v3 offset:7632
    s_waitcnt lgkmcnt(6)
    v_mfma_f32_32x32x16_bf16 v[64:79], v[18:21], v[34:37], v[64:79]
    v_mfma_f32_32x32x16_bf16 v[64:79], v[22:25], v[38:41], v[64:79]
    ds_read_b64 v[18:19], v2 offset:14128
    ds_read_b64 v[20:21], v2 offset:14136
    ds_read_b64 v[22:23], v2 offset:14160
    ds_read_b64 v[24:25], v2 offset:14168
    ds_read_b128 v[34:37], v3 offset:7520
    ds_read_b128 v[38:41], v3 offset:7552
    s_waitcnt lgkmcnt(6)
    v_mfma_f32_32x32x16_bf16 v[80:95], v[10:13], v[26:29], v[80:95]
    v_mfma_f32_32x32x16_bf16 v[80:95], v[14:17], v[30:33], v[80:95]
    ds_read_b64 v[10:11], v2 offset:14064
    ds_read_b64 v[12:13], v2 offset:14072
    ds_read_b64 v[14:15], v2 offset:14096
    ds_read_b64 v[16:17], v2 offset:14104
    ds_read_b128 v[26:29], v3 offset:7440
    ds_read_b128 v[30:33], v3 offset:7472
    s_waitcnt lgkmcnt(6)
    v_mfma_f32_32x32x16_bf16 v[80:95], v[18:21], v[34:37], v[80:95]
    v_mfma_f32_32x32x16_bf16 v[80:95], v[22:25], v[38:41], v[80:95]
    ds_read_b64 v[18:19], v2 offset:14000
    ds_read_b64 v[20:21], v2 offset:14008
    ds_read_b64 v[22:23], v2 offset:14032
    ds_read_b64 v[24:25], v2 offset:14040
    ds_read_b128 v[34:37], v3 offset:7360
    ds_read_b128 v[38:41], v3 offset:7392
    s_waitcnt lgkmcnt(6)
    v_mfma_f32_32x32x16_bf16 v[80:95], v[10:13], v[26:29], v[80:95]
    v_mfma_f32_32x32x16_bf16 v[80:95], v[14:17], v[30:33], v[80:95]
    ds_read_b64 v[10:11], v2 offset:13936
    ds_read_b64 v[12:13], v2 offset:13944
    ds_read_b64 v[14:15], v2 offset:13968
    ds_read_b64 v[16:17], v2 offset:13976
    ds_read_b128 v[26:29], v3 offset:7280
    ds_read_b128 v[30:33], v3 offset:7312
    s_waitcnt lgkmcnt(6)
    v_mfma_f32_32x32x16_bf16 v[80:95], v[18:21], v[34:37], v[80:95]
    v_mfma_f32_32x32x16_bf16 v[80:95], v[22:25], v[38:41], v[80:95]
    ds_read_b64 v[18:19], v2 offset:13872
    ds_read_b64 v[20:21], v2 offset:13880
    ds_read_b64 v[22:23], v2 offset:13904
    ds_read_b64 v[24:25], v2 offset:13912
    ds_read_b128 v[34:37], v3 offset:7200
    ds_read_b128 v[38:41], v3 offset:7232
    s_waitcnt lgkmcnt(6)
    v_mfma_f32_32x32x16_bf16 v[80:95], v[10:13], v[26:29], v[80:95]
    v_mfma_f32_32x32x16_bf16 v[80:95], v[14:17], v[30:33], v[80:95]
    ds_read_b64 v[10:11], v2 offset:13808
    ds_read_b64 v[12:13], v2 offset:13816
    ds_read_b64 v[14:15], v2 offset:13840
    ds_read_b64 v[16:17], v2 offset:13848
    ds_read_b128 v[26:29], v3 offset:7120
    ds_read_b128 v[30:33], v3 offset:7152
    s_waitcnt lgkmcnt(6)
    v_mfma_f32_32x32x16_bf16 v[80:95], v[18:21], v[34:37], v[80:95]
    v_mfma_f32_32x32x16_bf16 v[80:95], v[22:25], v[38:41], v[80:95]
    ds_read_b64 v[18:19], v2 offset:13744
    ds_read_b64 v[20:21], v2 offset:13752
    ds_read_b64 v[22:23], v2 offset:13776
    ds_read_b64 v[24:25], v2 offset:13784
    ds_read_b128 v[34:37], v3 offset:7040
    ds_read_b128 v[38:41], v3 offset:7072
    s_waitcnt lgkmcnt(6)
    v_mfma_f32_32x32x16_bf16 v[80:95], v[10:13], v[26:29], v[80:95]
    v_mfma_f32_32x32x16_bf16 v[80:95], v[14:17], v[30:33], v[80:95]
    ds_read_b64 v[10:11], v2 offset:13680
    ds_read_b64 v[12:13], v2 offset:13688
    ds_read_b64 v[14:15], v2 offset:13712
    ds_read_b64 v[16:17], v2 offset:13720
    ds_read_b128 v[26:29], v3 offset:6960
    ds_read_b128 v[30:33], v3 offset:6992
    s_waitcnt lgkmcnt(6)
    v_mfma_f32_32x32x16_bf16 v[80:95], v[18:21], v[34:37], v[80:95]
    v_mfma_f32_32x32x16_bf16 v[80:95], v[22:25], v[38:41], v[80:95]
    ds_read_b64 v[18:19], v2 offset:13616
    ds_read_b64 v[20:21], v2 offset:13624
    ds_read_b64 v[22:23], v2 offset:13648
    ds_read_b64 v[24:25], v2 offset:13656
    ds_read_b128 v[34:37], v3 offset:6880
    ds_read_b128 v[38:41], v3 offset:6912
    s_waitcnt lgkmcnt(6)
    v_mfma_f32_32x32x16_bf16 v[80:95], v[10:13], v[26:29], v[80:95]
    v_mfma_f32_32x32x16_bf16 v[80:95], v[14:17], v[30:33], v[80:95]
    ds_read_b64 v[10:11], v2 offset:13552
    ds_read_b64 v[12:13], v2 offset:13560
    ds_read_b64 v[14:15], v2 offset:13584
    ds_read_b64 v[16:17], v2 offset:13592
    ds_read_b128 v[26:29], v3 offset:6800
    ds_read_b128 v[30:33], v3 offset:6832
    s_waitcnt lgkmcnt(6)
    v_mfma_f32_32x32x16_bf16 v[80:95], v[18:21], v[34:37], v[80:95]
    v_mfma_f32_32x32x16_bf16 v[80:95], v[22:25], v[38:41], v[80:95]
    ds_read_b64 v[18:19], v2 offset:13488
    ds_read_b64 v[20:21], v2 offset:13496
    ds_read_b64 v[22:23], v2 offset:13520
    ds_read_b64 v[24:25], v2 offset:13528
    ds_read_b128 v[34:37], v3 offset:6720
    ds_read_b128 v[38:41], v3 offset:6752
    s_waitcnt lgkmcnt(6)
    v_mfma_f32_32x32x16_bf16 v[80:95], v[10:13], v[26:29], v[80:95]
    v_mfma_f32_32x32x16_bf16 v[80:95], v[14:17], v[30:33], v[80:95]
    ds_read_b64 v[10:11], v2 offset:13424
    ds_read_b64 v[12:13], v2 offset:13432
    ds_read_b64 v[14:15], v2 offset:13456
    ds_read_b64 v[16:17], v2 offset:13464
    ds_read_b128 v[26:29], v3 offset:6640
    ds_read_b128 v[30:33], v3 offset:6672
    s_waitcnt lgkmcnt(6)
    v_mfma_f32_32x32x16_bf16 v[80:95], v[18:21], v[34:37], v[80:95]
    v_mfma_f32_32x32x16_bf16 v[80:95], v[22:25], v[38:41], v[80:95]
    ds_read_b64 v[18:19], v2 offset:13360
    ds_read_b64 v[20:21], v2 offset:13368
    ds_read_b64 v[22:23], v2 offset:13392
    ds_read_b64 v[24:25], v2 offset:13400
    ds_read_b128 v[34:37], v3 offset:6560
    ds_read_b128 v[38:41], v3 offset:6592
    s_waitcnt lgkmcnt(6)
    v_mfma_f32_32x32x16_bf16 v[80:95], v[10:13], v[26:29], v[80:95]
    v_mfma_f32_32x32x16_bf16 v[80:95], v[14:17], v[30:33], v[80:95]
    ds_read_b64 v[10:11], v2 offset:13296
    ds_read_b64 v[12:13], v2 offset:13304
    ds_read_b64 v[14:15], v2 offset:13328
    ds_read_b64 v[16:17], v2 offset:13336
    ds_read_b128 v[26:29], v3 offset:6480
    ds_read_b128 v[30:33], v3 offset:6512
    s_waitcnt lgkmcnt(6)
    v_mfma_f32_32x32x16_bf16 v[80:95], v[18:21], v[34:37], v[80:95]
    v_mfma_f32_32x32x16_bf16 v[80:95], v[22:25], v[38:41], v[80:95]
    ds_read_b64 v[18:19], v2 offset:13232
    ds_read_b64 v[20:21], v2 offset:13240
    ds_read_b64 v[22:23], v2 offset:13264
    ds_read_b64 v[24:25], v2 offset:13272
    ds_read_b128 v[34:37], v3 offset:6400
    ds_read_b128 v[38:41], v3 offset:6432
    s_waitcnt lgkmcnt(6)
    v_mfma_f32_32x32x16_bf16 v[80:95], v[10:13], v[26:29], v[80:95]
    v_mfma_f32_32x32x16_bf16 v[80:95], v[14:17], v[30:33], v[80:95]
    s_waitcnt lgkmcnt(0)
    v_mfma_f32_32x32x16_bf16 v[80:95], v[18:21], v[34:37], v[80:95]
    v_mfma_f32_32x32x16_bf16 v[80:95], v[22:25], v[38:41], v[80:95]
    s_nop 7
    s_nop 7
    s_barrier
    ds_write_b128 v7, v[64:67] offset:10160
    ds_write_b128 v7, v[80:83] offset:14256
    ds_write_b128 v7, v[68:71] offset:11184
    ds_write_b128 v7, v[84:87] offset:15280
    ds_write_b128 v7, v[72:75] offset:12208
    ds_write_b128 v7, v[88:91] offset:16304
    ds_write_b128 v7, v[76:79] offset:13232
    ds_write_b128 v7, v[92:95] offset:17328
    s_waitcnt lgkmcnt(0)
    s_barrier
    s_branch Lce_77
Lcw_79:
    s_cmp_lg_u32 s62, 2
    s_cbranch_scc1 Lcw_80
    ds_read_b64 v[10:11], v2 offset:13168
    ds_read_b64 v[12:13], v2 offset:13176
    ds_read_b64 v[14:15], v2 offset:13200
    ds_read_b64 v[16:17], v2 offset:13208
    ds_read_b128 v[26:29], v3 offset:6320
    ds_read_b128 v[30:33], v3 offset:6352
    ds_read_b64 v[18:19], v2 offset:13104
    ds_read_b64 v[20:21], v2 offset:13112
    ds_read_b64 v[22:23], v2 offset:13136
    ds_read_b64 v[24:25], v2 offset:13144
    ds_read_b128 v[34:37], v3 offset:6240
    ds_read_b128 v[38:41], v3 offset:6272
    s_waitcnt lgkmcnt(6)
    v_mfma_f32_32x32x16_bf16 v[80:95], v[10:13], v[26:29], v[80:95]
    v_mfma_f32_32x32x16_bf16 v[80:95], v[14:17], v[30:33], v[80:95]
    ds_read_b64 v[10:11], v2 offset:13040
    ds_read_b64 v[12:13], v2 offset:13048
    ds_read_b64 v[14:15], v2 offset:13072
    ds_read_b64 v[16:17], v2 offset:13080
    ds_read_b128 v[26:29], v3 offset:6160
    ds_read_b128 v[30:33], v3 offset:6192
    s_waitcnt lgkmcnt(6)
    v_mfma_f32_32x32x16_bf16 v[80:95], v[18:21], v[34:37], v[80:95]
    v_mfma_f32_32x32x16_bf16 v[80:95], v[22:25], v[38:41], v[80:95]
    ds_read_b64 v[18:19], v2 offset:12976
    ds_read_b64 v[20:21], v2 offset:12984
    ds_read_b64 v[22:23], v2 offset:13008
    ds_read_b64 v[24:25], v2 offset:13016
    ds_read_b128 v[34:37], v3 offset:6080
    ds_read_b128 v[38:41], v3 offset:6112
    s_waitcnt lgkmcnt(6)
    v_mfma_f32_32x32x16_bf16 v[80:95], v[10:13], v[26:29], v[80:95]
    v_mfma_f32_32x32x16_bf16 v[80:95], v[14:17], v[30:33], v[80:95]
    ds_read_b64 v[10:11], v2 offset:12912
    ds_read_b64 v[12:13], v2 offset:12920
    ds_read_b64 v[14:15], v2 offset:12944
    ds_read_b64 v[16:17], v2 offset:12952
    ds_read_b128 v[26:29], v3 offset:6000
    ds_read_b128 v[30:33], v3 offset:6032
    s_waitcnt lgkmcnt(6)
    v_mfma_f32_32x32x16_bf16 v[80:95], v[18:21], v[34:37], v[80:95]
    v_mfma_f32_32x32x16_bf16 v[80:95], v[22:25], v[38:41], v[80:95]
    ds_read_b64 v[18:19], v2 offset:12848
    ds_read_b64 v[20:21], v2 offset:12856
    ds_read_b64 v[22:23], v2 offset:12880
    ds_read_b64 v[24:25], v2 offset:12888
    ds_read_b128 v[34:37], v3 offset:5920
    ds_read_b128 v[38:41], v3 offset:5952
    s_waitcnt lgkmcnt(6)
    v_mfma_f32_32x32x16_bf16 v[80:95], v[10:13], v[26:29], v[80:95]
    v_mfma_f32_32x32x16_bf16 v[80:95], v[14:17], v[30:33], v[80:95]
    ds_read_b64 v[10:11], v2 offset:12784
    ds_read_b64 v[12:13], v2 offset:12792
    ds_read_b64 v[14:15], v2 offset:12816
    ds_read_b64 v[16:17], v2 offset:12824
    ds_read_b128 v[26:29], v3 offset:5840
    ds_read_b128 v[30:33], v3 offset:5872
    s_waitcnt lgkmcnt(6)
    v_mfma_f32_32x32x16_bf16 v[80:95], v[18:21], v[34:37], v[80:95]
    v_mfma_f32_32x32x16_bf16 v[80:95], v[22:25], v[38:41], v[80:95]
    ds_read_b64 v[18:19], v2 offset:12720
    ds_read_b64 v[20:21], v2 offset:12728
    ds_read_b64 v[22:23], v2 offset:12752
    ds_read_b64 v[24:25], v2 offset:12760
    ds_read_b128 v[34:37], v3 offset:5760
    ds_read_b128 v[38:41], v3 offset:5792
    s_waitcnt lgkmcnt(6)
    v_mfma_f32_32x32x16_bf16 v[80:95], v[10:13], v[26:29], v[80:95]
    v_mfma_f32_32x32x16_bf16 v[80:95], v[14:17], v[30:33], v[80:95]
    ds_read_b64 v[10:11], v2 offset:12656
    ds_read_b64 v[12:13], v2 offset:12664
    ds_read_b64 v[14:15], v2 offset:12688
    ds_read_b64 v[16:17], v2 offset:12696
    ds_read_b128 v[26:29], v3 offset:5680
    ds_read_b128 v[30:33], v3 offset:5712
    s_waitcnt lgkmcnt(6)
    v_mfma_f32_32x32x16_bf16 v[80:95], v[18:21], v[34:37], v[80:95]
    v_mfma_f32_32x32x16_bf16 v[80:95], v[22:25], v[38:41], v[80:95]
    ds_read_b64 v[18:19], v2 offset:12592
    ds_read_b64 v[20:21], v2 offset:12600
    ds_read_b64 v[22:23], v2 offset:12624
    ds_read_b64 v[24:25], v2 offset:12632
    ds_read_b128 v[34:37], v3 offset:5600
    ds_read_b128 v[38:41], v3 offset:5632
    s_waitcnt lgkmcnt(6)
    v_mfma_f32_32x32x16_bf16 v[80:95], v[10:13], v[26:29], v[80:95]
    v_mfma_f32_32x32x16_bf16 v[80:95], v[14:17], v[30:33], v[80:95]
    ds_read_b64 v[10:11], v2 offset:12528
    ds_read_b64 v[12:13], v2 offset:12536
    ds_read_b64 v[14:15], v2 offset:12560
    ds_read_b64 v[16:17], v2 offset:12568
    ds_read_b128 v[26:29], v3 offset:5520
    ds_read_b128 v[30:33], v3 offset:5552
    s_waitcnt lgkmcnt(6)
    v_mfma_f32_32x32x16_bf16 v[80:95], v[18:21], v[34:37], v[80:95]
    v_mfma_f32_32x32x16_bf16 v[80:95], v[22:25], v[38:41], v[80:95]
    ds_read_b64 v[18:19], v2 offset:12464
    ds_read_b64 v[20:21], v2 offset:12472
    ds_read_b64 v[22:23], v2 offset:12496
    ds_read_b64 v[24:25], v2 offset:12504
    ds_read_b128 v[34:37], v3 offset:5440
    ds_read_b128 v[38:41], v3 offset:5472
    s_waitcnt lgkmcnt(6)
    v_mfma_f32_32x32x16_bf16 v[80:95], v[10:13], v[26:29], v[80:95]
    v_mfma_f32_32x32x16_bf16 v[80:95], v[14:17], v[30:33], v[80:95]
    ds_read_b64 v[10:11], v2 offset:12400
    ds_read_b64 v[12:13], v2 offset:12408
    ds_read_b64 v[14:15], v2 offset:12432
    ds_read_b64 v[16:17], v2 offset:12440
    ds_read_b128 v[26:29], v3 offset:5360
    ds_read_b128 v[30:33], v3 offset:5392
    s_waitcnt lgkmcnt(6)
    v_mfma_f32_32x32x16_bf16 v[80:95], v[18:21], v[34:37], v[80:95]
    v_mfma_f32_32x32x16_bf16 v[80:95], v[22:25], v[38:41], v[80:95]
    ds_read_b64 v[18:19], v2 offset:12336
    ds_read_b64 v[20:21], v2 offset:12344
    ds_read_b64 v[22:23], v2 offset:12368
    ds_read_b64 v[24:25], v2 offset:12376
    ds_read_b128 v[34:37], v3 offset:5280
    ds_read_b128 v[38:41], v3 offset:5312
    s_waitcnt lgkmcnt(6)
    v_mfma_f32_32x32x16_bf16 v[80:95], v[10:13], v[26:29], v[80:95]
    v_mfma_f32_32x32x16_bf16 v[80:95], v[14:17], v[30:33], v[80:95]
    ds_read_b64 v[10:11], v2 offset:12272
    ds_read_b64 v[12:13], v2 offset:12280
    ds_read_b64 v[14:15], v2 offset:12304
    ds_read_b64 v[16:17], v2 offset:12312
    ds_read_b128 v[26:29], v3 offset:5200
    ds_read_b128 v[30:33], v3 offset:5232
    s_waitcnt lgkmcnt(6)
    v_mfma_f32_32x32x16_bf16 v[80:95], v[18:21], v[34:37], v[80:95]
    v_mfma_f32_32x32x16_bf16 v[80:95], v[22:25], v[38:41], v[80:95]
    ds_read_b64 v[18:19], v2 offset:12208
    ds_read_b64 v[20:21], v2 offset:12216
    ds_read_b64 v[22:23], v2 offset:12240
    ds_read_b64 v[24:25], v2 offset:12248
    ds_read_b128 v[34:37], v3 offset:5120
    ds_read_b128 v[38:41], v3 offset:5152
    s_waitcnt lgkmcnt(6)
    v_mfma_f32_32x32x16_bf16 v[80:95], v[10:13], v[26:29], v[80:95]
    v_mfma_f32_32x32x16_bf16 v[80:95], v[14:17], v[30:33], v[80:95]
    ds_read_b64 v[10:11], v2 offset:12144
    ds_read_b64 v[12:13], v2 offset:12152
    ds_read_b64 v[14:15], v2 offset:12176
    ds_read_b64 v[16:17], v2 offset:12184
    ds_read_b128 v[26:29], v3 offset:5040
    ds_read_b128 v[30:33], v3 offset:5072
    s_waitcnt lgkmcnt(6)
    v_mfma_f32_32x32x16_bf16 v[80:95], v[18:21], v[34:37], v[80:95]
    v_mfma_f32_32x32x16_bf16 v[80:95], v[22:25], v[38:41], v[80:95]
    ds_read_b64 v[18:19], v2 offset:12080
    ds_read_b64 v[20:21], v2 offset:12088
    ds_read_b64 v[22:23], v2 offset:12112
    ds_read_b64 v[24:25], v2 offset:12120
    ds_read_b128 v[34:37], v3 offset:4960
    ds_read_b128 v[38:41], v3 offset:4992
    s_waitcnt lgkmcnt(6)
    v_mfma_f32_32x32x16_bf16 v[80:95], v[10:13], v[26:29], v[80:95]
    v_mfma_f32_32x32x16_bf16 v[80:95], v[14:17], v[30:33], v[80:95]
    ds_read_b64 v[10:11], v2 offset:12016
    ds_read_b64 v[12:13], v2 offset:12024
    ds_read_b64 v[14:15], v2 offset:12048
    ds_read_b64 v[16:17], v2 offset:12056
    ds_read_b128 v[26:29], v3 offset:4880
    ds_read_b128 v[30:33], v3 offset:4912
    s_waitcnt lgkmcnt(6)
    v_mfma_f32_32x32x16_bf16 v[80:95], v[18:21], v[34:37], v[80:95]
    v_mfma_f32_32x32x16_bf16 v[80:95], v[22:25], v[38:41], v[80:95]
    ds_read_b64 v[18:19], v2 offset:11952
    ds_read_b64 v[20:21], v2 offset:11960
    ds_read_b64 v[22:23], v2 offset:11984
    ds_read_b64 v[24:25], v2 offset:11992
    ds_read_b128 v[34:37], v3 offset:4800
    ds_read_b128 v[38:41], v3 offset:4832
    s_waitcnt lgkmcnt(6)
    v_mfma_f32_32x32x16_bf16 v[80:95], v[10:13], v[26:29], v[80:95]
    v_mfma_f32_32x32x16_bf16 v[80:95], v[14:17], v[30:33], v[80:95]
    ds_read_b64 v[10:11], v2 offset:11888
    ds_read_b64 v[12:13], v2 offset:11896
    ds_read_b64 v[14:15], v2 offset:11920
    ds_read_b64 v[16:17], v2 offset:11928
    ds_read_b128 v[26:29], v3 offset:4720
    ds_read_b128 v[30:33], v3 offset:4752
    s_waitcnt lgkmcnt(6)
    v_mfma_f32_32x32x16_bf16 v[80:95], v[18:21], v[34:37], v[80:95]
    v_mfma_f32_32x32x16_bf16 v[80:95], v[22:25], v[38:41], v[80:95]
    ds_read_b64 v[18:19], v2 offset:11824
    ds_read_b64 v[20:21], v2 offset:11832
    ds_read_b64 v[22:23], v2 offset:11856
    ds_read_b64 v[24:25], v2 offset:11864
    ds_read_b128 v[34:37], v3 offset:4640
    ds_read_b128 v[38:41], v3 offset:4672
    s_waitcnt lgkmcnt(6)
    v_mfma_f32_32x32x16_bf16 v[80:95], v[10:13], v[26:29], v[80:95]
    v_mfma_f32_32x32x16_bf16 v[80:95], v[14:17], v[30:33], v[80:95]
    ds_read_b64 v[10:11], v2 offset:11760
    ds_read_b64 v[12:13], v2 offset:11768
    ds_read_b64 v[14:15], v2 offset:11792
    ds_read_b64 v[16:17], v2 offset:11800
    ds_read_b128 v[26:29], v3 offset:4560
    ds_read_b128 v[30:33], v3 offset:4592
    s_waitcnt lgkmcnt(6)
    v_mfma_f32_32x32x16_bf16 v[80:95], v[18:21], v[34:37], v[80:95]
    v_mfma_f32_32x32x16_bf16 v[80:95], v[22:25], v[38:41], v[80:95]
    ds_read_b64 v[18:19], v2 offset:11696
    ds_read_b64 v[20:21], v2 offset:11704
    ds_read_b64 v[22:23], v2 offset:11728
    ds_read_b64 v[24:25], v2 offset:11736
    ds_read_b128 v[34:37], v3 offset:4480
    ds_read_b128 v[38:41], v3 offset:4512
    s_waitcnt lgkmcnt(6)
    v_mfma_f32_32x32x16_bf16 v[80:95], v[10:13], v[26:29], v[80:95]
    v_mfma_f32_32x32x16_bf16 v[80:95], v[14:17], v[30:33], v[80:95]
    s_waitcnt lgkmcnt(0)
    v_mfma_f32_32x32x16_bf16 v[80:95], v[18:21], v[34:37], v[80:95]
    v_mfma_f32_32x32x16_bf16 v[80:95], v[22:25], v[38:41], v[80:95]
    s_nop 7
    s_nop 7
    s_barrier
    ds_write_b128 v7, v[80:83] offset:18352
    ds_write_b128 v7, v[84:87] offset:19376
    ds_write_b128 v7, v[88:91] offset:20400
    ds_write_b128 v7, v[92:95] offset:21424
    s_waitcnt lgkmcnt(0)
    s_barrier
    s_branch Lce_77
Lcw_80:
    ds_read_b64 v[10:11], v2 offset:11632
    ds_read_b64 v[12:13], v2 offset:11640
    ds_read_b64 v[14:15], v2 offset:11664
    ds_read_b64 v[16:17], v2 offset:11672
    ds_read_b128 v[26:29], v3 offset:4400
    ds_read_b128 v[30:33], v3 offset:4432
    ds_read_b64 v[18:19], v2 offset:11568
    ds_read_b64 v[20:21], v2 offset:11576
    ds_read_b64 v[22:23], v2 offset:11600
    ds_read_b64 v[24:25], v2 offset:11608
    ds_read_b128 v[34:37], v3 offset:4320
    ds_read_b128 v[38:41], v3 offset:4352
    s_waitcnt lgkmcnt(6)
    v_mfma_f32_32x32x16_bf16 v[80:95], v[10:13], v[26:29], v[80:95]
    v_mfma_f32_32x32x16_bf16 v[80:95], v[14:17], v[30:33], v[80:95]
    ds_read_b64 v[10:11], v2 offset:11504
    ds_read_b64 v[12:13], v2 offset:11512
    ds_read_b64 v[14:15], v2 offset:11536
    ds_read_b64 v[16:17], v2 offset:11544
    ds_read_b128 v[26:29], v3 offset:4240
    ds_read_b128 v[30:33], v3 offset:4272
    s_waitcnt lgkmcnt(6)
    v_mfma_f32_32x32x16_bf16 v[80:95], v[18:21], v[34:37], v[80:95]
    v_mfma_f32_32x32x16_bf16 v[80:95], v[22:25], v[38:41], v[80:95]
    ds_read_b64 v[18:19], v2 offset:11440
    ds_read_b64 v[20:21], v2 offset:11448
    ds_read_b64 v[22:23], v2 offset:11472
    ds_read_b64 v[24:25], v2 offset:11480
    ds_read_b128 v[34:37], v3 offset:4160
    ds_read_b128 v[38:41], v3 offset:4192
    s_waitcnt lgkmcnt(6)
    v_mfma_f32_32x32x16_bf16 v[80:95], v[10:13], v[26:29], v[80:95]
    v_mfma_f32_32x32x16_bf16 v[80:95], v[14:17], v[30:33], v[80:95]
    ds_read_b64 v[10:11], v2 offset:11376
    ds_read_b64 v[12:13], v2 offset:11384
    ds_read_b64 v[14:15], v2 offset:11408
    ds_read_b64 v[16:17], v2 offset:11416
    ds_read_b128 v[26:29], v3 offset:4080
    ds_read_b128 v[30:33], v3 offset:4112
    s_waitcnt lgkmcnt(6)
    v_mfma_f32_32x32x16_bf16 v[80:95], v[18:21], v[34:37], v[80:95]
    v_mfma_f32_32x32x16_bf16 v[80:95], v[22:25], v[38:41], v[80:95]
    ds_read_b64 v[18:19], v2 offset:11312
    ds_read_b64 v[20:21], v2 offset:11320
    ds_read_b64 v[22:23], v2 offset:11344
    ds_read_b64 v[24:25], v2 offset:11352
    ds_read_b128 v[34:37], v3 offset:4000
    ds_read_b128 v[38:41], v3 offset:4032
    s_waitcnt lgkmcnt(6)
    v_mfma_f32_32x32x16_bf16 v[80:95], v[10:13], v[26:29], v[80:95]
    v_mfma_f32_32x32x16_bf16 v[80:95], v[14:17], v[30:33], v[80:95]
    ds_read_b64 v[10:11], v2 offset:11248
    ds_read_b64 v[12:13], v2 offset:11256
    ds_read_b64 v[14:15], v2 offset:11280
    ds_read_b64 v[16:17], v2 offset:11288
    ds_read_b128 v[26:29], v3 offset:3920
    ds_read_b128 v[30:33], v3 offset:3952
    s_waitcnt lgkmcnt(6)
    v_mfma_f32_32x32x16_bf16 v[80:95], v[18:21], v[34:37], v[80:95]
    v_mfma_f32_32x32x16_bf16 v[80:95], v[22:25], v[38:41], v[80:95]
    ds_read_b64 v[18:19], v2 offset:11184
    ds_read_b64 v[20:21], v2 offset:11192
    ds_read_b64 v[22:23], v2 offset:11216
    ds_read_b64 v[24:25], v2 offset:11224
    ds_read_b128 v[34:37], v3 offset:3840
    ds_read_b128 v[38:41], v3 offset:3872
    s_waitcnt lgkmcnt(6)
    v_mfma_f32_32x32x16_bf16 v[80:95], v[10:13], v[26:29], v[80:95]
    v_mfma_f32_32x32x16_bf16 v[80:95], v[14:17], v[30:33], v[80:95]
    ds_read_b64 v[10:11], v2 offset:11120
    ds_read_b64 v[12:13], v2 offset:11128
    ds_read_b64 v[14:15], v2 offset:11152
    ds_read_b64 v[16:17], v2 offset:11160
    ds_read_b128 v[26:29], v3 offset:3760
    ds_read_b128 v[30:33], v3 offset:3792
    s_waitcnt lgkmcnt(6)
    v_mfma_f32_32x32x16_bf16 v[80:95], v[18:21], v[34:37], v[80:95]
    v_mfma_f32_32x32x16_bf16 v[80:95], v[22:25], v[38:41], v[80:95]
    ds_read_b64 v[18:19], v2 offset:11056
    ds_read_b64 v[20:21], v2 offset:11064
    ds_read_b64 v[22:23], v2 offset:11088
    ds_read_b64 v[24:25], v2 offset:11096
    ds_read_b128 v[34:37], v3 offset:3680
    ds_read_b128 v[38:41], v3 offset:3712
    s_waitcnt lgkmcnt(6)
    v_mfma_f32_32x32x16_bf16 v[80:95], v[10:13], v[26:29], v[80:95]
    v_mfma_f32_32x32x16_bf16 v[80:95], v[14:17], v[30:33], v[80:95]
    ds_read_b64 v[10:11], v2 offset:10992
    ds_read_b64 v[12:13], v2 offset:11000
    ds_read_b64 v[14:15], v2 offset:11024
    ds_read_b64 v[16:17], v2 offset:11032
    ds_read_b128 v[26:29], v3 offset:3600
    ds_read_b128 v[30:33], v3 offset:3632
    s_waitcnt lgkmcnt(6)
    v_mfma_f32_32x32x16_bf16 v[80:95], v[18:21], v[34:37], v[80:95]
    v_mfma_f32_32x32x16_bf16 v[80:95], v[22:25], v[38:41], v[80:95]
    ds_read_b64 v[18:19], v2 offset:10928
    ds_read_b64 v[20:21], v2 offset:10936
    ds_read_b64 v[22:23], v2 offset:10960
    ds_read_b64 v[24:25], v2 offset:10968
    ds_read_b128 v[34:37], v3 offset:3520
    ds_read_b128 v[38:41], v3 offset:3552
    s_waitcnt lgkmcnt(6)
    v_mfma_f32_32x32x16_bf16 v[80:95], v[10:13], v[26:29], v[80:95]
    v_mfma_f32_32x32x16_bf16 v[80:95], v[14:17], v[30:33], v[80:95]
    ds_read_b64 v[10:11], v2 offset:10864
    ds_read_b64 v[12:13], v2 offset:10872
    ds_read_b64 v[14:15], v2 offset:10896
    ds_read_b64 v[16:17], v2 offset:10904
    ds_read_b128 v[26:29], v3 offset:3440
    ds_read_b128 v[30:33], v3 offset:3472
    s_waitcnt lgkmcnt(6)
    v_mfma_f32_32x32x16_bf16 v[80:95], v[18:21], v[34:37], v[80:95]
    v_mfma_f32_32x32x16_bf16 v[80:95], v[22:25], v[38:41], v[80:95]
    ds_read_b64 v[18:19], v2 offset:10800
    ds_read_b64 v[20:21], v2 offset:10808
    ds_read_b64 v[22:23], v2 offset:10832
    ds_read_b64 v[24:25], v2 offset:10840
    ds_read_b128 v[34:37], v3 offset:3360
    ds_read_b128 v[38:41], v3 offset:3392
    s_waitcnt lgkmcnt(6)
    v_mfma_f32_32x32x16_bf16 v[80:95], v[10:13], v[26:29], v[80:95]
    v_mfma_f32_32x32x16_bf16 v[80:95], v[14:17], v[30:33], v[80:95]
    ds_read_b64 v[10:11], v2 offset:10736
    ds_read_b64 v[12:13], v2 offset:10744
    ds_read_b64 v[14:15], v2 offset:10768
    ds_read_b64 v[16:17], v2 offset:10776
    ds_read_b128 v[26:29], v3 offset:3280
    ds_read_b128 v[30:33], v3 offset:3312
    s_waitcnt lgkmcnt(6)
    v_mfma_f32_32x32x16_bf16 v[80:95], v[18:21], v[34:37], v[80:95]
    v_mfma_f32_32x32x16_bf16 v[80:95], v[22:25], v[38:41], v[80:95]
    ds_read_b64 v[18:19], v2 offset:10672
    ds_read_b64 v[20:21], v2 offset:10680
    ds_read_b64 v[22:23], v2 offset:10704
    ds_read_b64 v[24:25], v2 offset:10712
    ds_read_b128 v[34:37], v3 offset:3200
    ds_read_b128 v[38:41], v3 offset:3232
    s_waitcnt lgkmcnt(6)
    v_mfma_f32_32x32x16_bf16 v[80:95], v[10:13], v[26:29], v[80:95]
    v_mfma_f32_32x32x16_bf16 v[80:95], v[14:17], v[30:33], v[80:95]
    ds_read_b64 v[10:11], v2 offset:10608
    ds_read_b64 v[12:13], v2 offset:10616
    ds_read_b64 v[14:15], v2 offset:10640
    ds_read_b64 v[16:17], v2 offset:10648
    ds_read_b128 v[26:29], v3 offset:3120
    ds_read_b128 v[30:33], v3 offset:3152
    s_waitcnt lgkmcnt(6)
    v_mfma_f32_32x32x16_bf16 v[80:95], v[18:21], v[34:37], v[80:95]
    v_mfma_f32_32x32x16_bf16 v[80:95], v[22:25], v[38:41], v[80:95]
    ds_read_b64 v[18:19], v2 offset:10544
    ds_read_b64 v[20:21], v2 offset:10552
    ds_read_b64 v[22:23], v2 offset:10576
    ds_read_b64 v[24:25], v2 offset:10584
    ds_read_b128 v[34:37], v3 offset:3040
    ds_read_b128 v[38:41], v3 offset:3072
    s_waitcnt lgkmcnt(6)
    v_mfma_f32_32x32x16_bf16 v[80:95], v[10:13], v[26:29], v[80:95]
    v_mfma_f32_32x32x16_bf16 v[80:95], v[14:17], v[30:33], v[80:95]
    ds_read_b64 v[10:11], v2 offset:10480
    ds_read_b64 v[12:13], v2 offset:10488
    ds_read_b64 v[14:15], v2 offset:10512
    ds_read_b64 v[16:17], v2 offset:10520
    ds_read_b128 v[26:29], v3 offset:2960
    ds_read_b128 v[30:33], v3 offset:2992
    s_waitcnt lgkmcnt(6)
    v_mfma_f32_32x32x16_bf16 v[80:95], v[18:21], v[34:37], v[80:95]
    v_mfma_f32_32x32x16_bf16 v[80:95], v[22:25], v[38:41], v[80:95]
    ds_read_b64 v[18:19], v2 offset:10416
    ds_read_b64 v[20:21], v2 offset:10424
    ds_read_b64 v[22:23], v2 offset:10448
    ds_read_b64 v[24:25], v2 offset:10456
    ds_read_b128 v[34:37], v3 offset:2880
    ds_read_b128 v[38:41], v3 offset:2912
    s_waitcnt lgkmcnt(6)
    v_mfma_f32_32x32x16_bf16 v[80:95], v[10:13], v[26:29], v[80:95]
    v_mfma_f32_32x32x16_bf16 v[80:95], v[14:17], v[30:33], v[80:95]
    ds_read_b64 v[10:11], v2 offset:10352
    ds_read_b64 v[12:13], v2 offset:10360
    ds_read_b64 v[14:15], v2 offset:10384
    ds_read_b64 v[16:17], v2 offset:10392
    ds_read_b128 v[26:29], v3 offset:2800
    ds_read_b128 v[30:33], v3 offset:2832
    s_waitcnt lgkmcnt(6)
    v_mfma_f32_32x32x16_bf16 v[80:95], v[18:21], v[34:37], v[80:95]
    v_mfma_f32_32x32x16_bf16 v[80:95], v[22:25], v[38:41], v[80:95]
    ds_read_b64 v[18:19], v2 offset:10288
    ds_read_b64 v[20:21], v2 offset:10296
    ds_read_b64 v[22:23], v2 offset:10320
    ds_read_b64 v[24:25], v2 offset:10328
    ds_read_b128 v[34:37], v3 offset:2720
    ds_read_b128 v[38:41], v3 offset:2752
    s_waitcnt lgkmcnt(6)
    v_mfma_f32_32x32x16_bf16 v[80:95], v[10:13], v[26:29], v[80:95]
    v_mfma_f32_32x32x16_bf16 v[80:95], v[14:17], v[30:33], v[80:95]
    ds_read_b64 v[10:11], v2 offset:10224
    ds_read_b64 v[12:13], v2 offset:10232
    ds_read_b64 v[14:15], v2 offset:10256
    ds_read_b64 v[16:17], v2 offset:10264
    ds_read_b128 v[26:29], v3 offset:2640
    ds_read_b128 v[30:33], v3 offset:2672
    s_waitcnt lgkmcnt(6)
    v_mfma_f32_32x32x16_bf16 v[80:95], v[18:21], v[34:37], v[80:95]
    v_mfma_f32_32x32x16_bf16 v[80:95], v[22:25], v[38:41], v[80:95]
    ds_read_b64 v[18:19], v2 offset:10160
    ds_read_b64 v[20:21], v2 offset:10168
    ds_read_b64 v[22:23], v2 offset:10192
    ds_read_b64 v[24:25], v2 offset:10200
    ds_read_b128 v[34:37], v3 offset:2560
    ds_read_b128 v[38:41], v3 offset:2592
    s_waitcnt lgkmcnt(6)
    v_mfma_f32_32x32x16_bf16 v[80:95], v[10:13], v[26:29], v[80:95]
    v_mfma_f32_32x32x16_bf16 v[80:95], v[14:17], v[30:33], v[80:95]
    s_waitcnt lgkmcnt(0)
    v_mfma_f32_32x32x16_bf16 v[80:95], v[18:21], v[34:37], v[80:95]
    v_mfma_f32_32x32x16_bf16 v[80:95], v[22:25], v[38:41], v[80:95]
    s_nop 7
    s_nop 7
    s_barrier
    s_waitcnt lgkmcnt(0)
    s_barrier
    ds_read_b128 v[64:67], v7 offset:14256
    ds_read_b128 v[104:107], v7 offset:18352
    ds_read_b128 v[68:71], v7 offset:15280
    ds_read_b128 v[108:111], v7 offset:19376
    ds_read_b128 v[72:75], v7 offset:16304
    ds_read_b128 v[112:115], v7 offset:20400
    ds_read_b128 v[76:79], v7 offset:17328
    ds_read_b128 v[116:119], v7 offset:21424
    s_waitcnt lgkmcnt(0)
    v_add_f32 v64, v64, v80
    v_add_f32 v64, v64, v104
    v_add_f32 v65, v65, v81
    v_add_f32 v65, v65, v105
    v_add_f32 v66, v66, v82
    v_add_f32 v66, v66, v106
    v_add_f32 v67, v67, v83
    v_add_f32 v67, v67, v107
    v_add_f32 v68, v68, v84
    v_add_f32 v68, v68, v108
    v_add_f32 v69, v69, v85
    v_add_f32 v69, v69, v109
    v_add_f32 v70, v70, v86
    v_add_f32 v70, v70, v110
    v_add_f32 v71, v71, v87
    v_add_f32 v71, v71, v111
    v_add_f32 v72, v72, v88
    v_add_f32 v72, v72, v112
    v_add_f32 v73, v73, v89
    v_add_f32 v73, v73, v113
    v_add_f32 v74, v74, v90
    v_add_f32 v74, v74, v114
    v_add_f32 v75, v75, v91
    v_add_f32 v75, v75, v115
    v_add_f32 v76, v76, v92
    v_add_f32 v76, v76, v116
    v_add_f32 v77, v77, v93
    v_add_f32 v77, v77, v117
    v_add_f32 v78, v78, v94
    v_add_f32 v78, v78, v118
    v_add_f32 v79, v79, v95
    v_add_f32 v79, v79, v119
    s_mov_b32 s69, 1
Lc2_76:
    s_mul_i32 s70, s69, 2560
    s_add_u32 s70, s70, s66
    v_mul_u32_u24 v3, 80, v5
    v_lshl_add_u32 v3, v6, 3, v3
    v_add_u32 v3, s70, v3
    v_lshlrev_b32 v4, 6, v5
    v_lshl_add_u32 v4, v6, 3, v4
    s_lshl_b32 s70, s69, 11
    s_add_u32 s65, s65, s70
    s_add_u32 s65, s65, 8388608

    ds_read_b64 v[10:11], v3 offset:5040
    ds_read_b64 v[12:13], v3 offset:5056
    ds_read_b64 v[14:15], v3 offset:5072
    ds_read_b64 v[16:17], v3 offset:5088
    s_waitcnt lgkmcnt(0)
    v_cvt_pk_bf16_f32 v26, v64, v65
    v_cvt_pk_bf16_f32 v27, v66, v67
    v_lshlrev_b32 v42, 16, v10
    v_lshlrev_b32 v46, 16, v26
    v_mul_f32 v42, s54, v42
    v_and_b32 v43, 0xffff0000, v10
    v_and_b32 v47, 0xffff0000, v26
    v_mul_f32 v43, s54, v43
    v_lshlrev_b32 v44, 16, v11
    v_lshlrev_b32 v48, 16, v27
    v_mul_f32 v44, s54, v44
    v_and_b32 v45, 0xffff0000, v11
    v_and_b32 v49, 0xffff0000, v27
    v_mul_f32 v45, s54, v45
    v_cvt_pk_bf16_f32 v28, v42, v43
    v_cvt_pk_bf16_f32 v29, v44, v45
    v_lshlrev_b32 v42, 16, v28
    v_and_b32 v43, 0xffff0000, v28
    v_lshlrev_b32 v44, 16, v29
    v_and_b32 v45, 0xffff0000, v29
    v_add_f32 v42, v42, v46
    v_add_f32 v43, v43, v47
    v_add_f32 v44, v44, v48
    v_add_f32 v45, v45, v49
    v_cvt_pk_bf16_f32 v30, v42, v43
    v_cvt_pk_bf16_f32 v31, v44, v45
    buffer_store_dwordx2 v[30:31], v4, s[24:27], s65 offen offset:0
    s_nop 1

    v_cvt_pk_bf16_f32 v26, v68, v69
    v_cvt_pk_bf16_f32 v27, v70, v71
    v_lshlrev_b32 v42, 16, v12
    v_lshlrev_b32 v46, 16, v26
    v_mul_f32 v42, s54, v42
    v_and_b32 v43, 0xffff0000, v12
    v_and_b32 v47, 0xffff0000, v26
    v_mul_f32 v43, s54, v43
    v_lshlrev_b32 v44, 16, v13
    v_lshlrev_b32 v48, 16, v27
    v_mul_f32 v44, s54, v44
    v_and_b32 v45, 0xffff0000, v13
    v_and_b32 v49, 0xffff0000, v27
    v_mul_f32 v45, s54, v45
    v_cvt_pk_bf16_f32 v28, v42, v43
    v_cvt_pk_bf16_f32 v29, v44, v45
    v_lshlrev_b32 v42, 16, v28
    v_and_b32 v43, 0xffff0000, v28
    v_lshlrev_b32 v44, 16, v29
    v_and_b32 v45, 0xffff0000, v29
    v_add_f32 v42, v42, v46
    v_add_f32 v43, v43, v47
    v_add_f32 v44, v44, v48
    v_add_f32 v45, v45, v49
    v_cvt_pk_bf16_f32 v32, v42, v43
    v_cvt_pk_bf16_f32 v33, v44, v45
    buffer_store_dwordx2 v[32:33], v4, s[24:27], s65 offen offset:16
    s_nop 1

    v_cvt_pk_bf16_f32 v26, v72, v73
    v_cvt_pk_bf16_f32 v27, v74, v75
    v_lshlrev_b32 v42, 16, v14
    v_lshlrev_b32 v46, 16, v26
    v_mul_f32 v42, s54, v42
    v_and_b32 v43, 0xffff0000, v14
    v_and_b32 v47, 0xffff0000, v26
    v_mul_f32 v43, s54, v43
    v_lshlrev_b32 v44, 16, v15
    v_lshlrev_b32 v48, 16, v27
    v_mul_f32 v44, s54, v44
    v_and_b32 v45, 0xffff0000, v15
    v_and_b32 v49, 0xffff0000, v27
    v_mul_f32 v45, s54, v45
    v_cvt_pk_bf16_f32 v28, v42, v43
    v_cvt_pk_bf16_f32 v29, v44, v45
    v_lshlrev_b32 v42, 16, v28
    v_and_b32 v43, 0xffff0000, v28
    v_lshlrev_b32 v44, 16, v29
    v_and_b32 v45, 0xffff0000, v29
    v_add_f32 v42, v42, v46
    v_add_f32 v43, v43, v47
    v_add_f32 v44, v44, v48
    v_add_f32 v45, v45, v49
    v_cvt_pk_bf16_f32 v30, v42, v43
    v_cvt_pk_bf16_f32 v31, v44, v45
    buffer_store_dwordx2 v[30:31], v4, s[24:27], s65 offen offset:32
    s_nop 1

    v_cvt_pk_bf16_f32 v26, v76, v77
    v_cvt_pk_bf16_f32 v27, v78, v79
    v_lshlrev_b32 v42, 16, v16
    v_lshlrev_b32 v46, 16, v26
    v_mul_f32 v42, s54, v42
    v_and_b32 v43, 0xffff0000, v16
    v_and_b32 v47, 0xffff0000, v26
    v_mul_f32 v43, s54, v43
    v_lshlrev_b32 v44, 16, v17
    v_lshlrev_b32 v48, 16, v27
    v_mul_f32 v44, s54, v44
    v_and_b32 v45, 0xffff0000, v17
    v_and_b32 v49, 0xffff0000, v27
    v_mul_f32 v45, s54, v45
    v_cvt_pk_bf16_f32 v28, v42, v43
    v_cvt_pk_bf16_f32 v29, v44, v45
    v_lshlrev_b32 v42, 16, v28
    v_and_b32 v43, 0xffff0000, v28
    v_lshlrev_b32 v44, 16, v29
    v_and_b32 v45, 0xffff0000, v29
    v_add_f32 v42, v42, v46
    v_add_f32 v43, v43, v47
    v_add_f32 v44, v44, v48
    v_add_f32 v45, v45, v49
    v_cvt_pk_bf16_f32 v32, v42, v43
    v_cvt_pk_bf16_f32 v33, v44, v45
    buffer_store_dwordx2 v[32:33], v4, s[24:27], s65 offen offset:48
    s_nop 1

Lce_77:
    s_endpgm
Lexit_k2_kernel:
    s_endpgm
.globl gated_mix__ssm_conv_h3__sliding_block__prompt_kernel
.p2align 8
.type gated_mix__ssm_conv_h3__sliding_block__prompt_kernel,@function
gated_mix__ssm_conv_h3__sliding_block__prompt_kernel:

    s_cmp_ge_u32 s2, 256
    s_cbranch_scc1 Lexit_gated_mix__ssm_conv_h3__sliding_block__prompt_kernel
    s_load_dwordx2 s[4:5], s[0:1], 0
    s_load_dwordx2 s[6:7], s[0:1], 64
    s_load_dwordx2 s[8:9], s[0:1], 96

    s_and_b32 s24, s2, 31
    s_lshr_b32 s25, s2, 5
    v_and_b32 v1, 63, v0
    v_lshrrev_b32 v10, 6, v0
    s_nop 0
    v_readfirstlane_b32 s26, v10
    s_waitcnt lgkmcnt(0)
    s_and_b32 s27, s26, 1
    s_lshr_b32 s28, s26, 1

    s_add_u32 s12, s8, 6291456
    s_addc_u32 s13, s9, 0
    s_mov_b32 s14, 2097152
    s_mov_b32 s15, 0x00020000
    s_mov_b32 s16, s6
    s_mov_b32 s17, s7
    s_mov_b32 s18, 524288
    s_mov_b32 s19, 0x00020000

    s_mov_b32 s20, s8
    s_mov_b32 s21, s9
    s_mov_b32 s22, 16777216
    s_mov_b32 s23, 0x00020000

    v_lshrrev_b32 v10, 3, v0
    v_and_b32 v11, 7, v0
    s_lshl_b32 s29, s24, 6
    v_add_u32 v12, s29, v10
    v_lshlrev_b32 v12, 10, v12
    v_lshl_add_u32 v2, v11, 4, v12

    v_add_u32 v3, 32768, v2
    v_mul_u32_u24 v12, 144, v10
    v_lshl_add_u32 v6, v11, 4, v12

    v_lshrrev_b32 v10, 3, v0
    v_and_b32 v11, 7, v0
    s_mov_b32 s30, 1024
    v_mul_lo_u32 v12, s30, v10
    v_lshl_add_u32 v12, v11, 4, v12
    s_lshl_b32 s29, s25, 7
    v_add_u32 v4, s29, v12

    v_add_u32 v5, 32768, v4
    v_mul_u32_u24 v12, 192, v10
    v_lshl_add_u32 v7, v11, 4, v12
    v_add_u32 v7, 9216, v7

    v_and_b32 v10, 31, v1
    s_mul_i32 s29, s28, 32
    v_add_u32 v10, s29, v10
    v_mul_u32_u24 v10, 144, v10
    v_lshrrev_b32 v11, 5, v1
    v_lshl_add_u32 v8, v11, 4, v10

    v_lshrrev_b32 v10, 5, v1
    v_lshlrev_b32 v10, 3, v10
    v_bfe_u32 v11, v1, 2, 2
    v_add_u32 v10, v10, v11
    v_mul_u32_u24 v10, 192, v10
    v_bfe_u32 v11, v1, 4, 1
    v_lshlrev_b32 v11, 5, v11
    v_and_b32 v12, 3, v1
    v_lshlrev_b32 v12, 3, v12
    v_add3_u32 v10, v10, v11, v12
    s_mul_i32 s29, s27, 64
    s_add_u32 s29, s29, 9216
    v_add_u32 v9, s29, v10

    s_load_dwordx2 s[4:5], s[0:1], 0
    s_load_dwordx2 s[6:7], s[0:1], 80
    s_waitcnt lgkmcnt(0)
    s_mov_b32 s36, s4
    s_mov_b32 s37, s5
    s_mov_b32 s38, 2097152
    s_mov_b32 s39, 0x00020000
    s_mov_b32 s40, s6
    s_mov_b32 s41, s7
    s_mov_b32 s42, 2097152
    s_mov_b32 s43, 0x00020000
    v_and_b32 v216, 31, v1
    s_lshl_b32 s29, s25, 6
    s_lshl_b32 s30, s27, 5
    s_add_u32 s29, s29, s30
    v_add_u32 v216, s29, v216
    v_lshrrev_b32 v217, 5, v1
    s_lshl_b32 s30, s24, 6
    s_lshl_b32 s31, s28, 5
    s_add_u32 s30, s30, s31
    v_lshl_add_u32 v217, v217, 2, s30
    v_lshlrev_b32 v218, 12, v216
    v_lshl_add_u32 v218, v217, 1, v218
    v_lshlrev_b32 v219, 10, v217
    v_lshl_add_u32 v219, v216, 1, v219
    v_lshlrev_b32 v217, 2, v217
    s_mov_b32 s33, 8388608
    s_mov_b32 s34, 10485760

    buffer_load_dwordx2 v[208:209], v218, s[20:23], s33 offen offset:0
    buffer_load_dwordx4 v[176:179], v217, s[20:23], s34 offen offset:0
    buffer_load_dwordx2 v[210:211], v218, s[20:23], s33 offen offset:16
    buffer_load_dwordx4 v[180:183], v217, s[20:23], s34 offen offset:32
    buffer_load_dwordx2 v[212:213], v218, s[20:23], s33 offen offset:32
    buffer_load_dwordx4 v[184:187], v217, s[20:23], s34 offen offset:64
    buffer_load_dwordx2 v[214:215], v218, s[20:23], s33 offen offset:48
    buffer_load_dwordx4 v[188:191], v217, s[20:23], s34 offen offset:96
    s_mov_b32 s35, 0
    buffer_load_ushort v192, v219, s[36:39], s35 offen
    s_mov_b32 s35, 1024
    buffer_load_ushort v193, v219, s[36:39], s35 offen
    s_mov_b32 s35, 2048
    buffer_load_ushort v194, v219, s[36:39], s35 offen
    s_mov_b32 s35, 3072
    buffer_load_ushort v195, v219, s[36:39], s35 offen
    s_mov_b32 s35, 8192
    buffer_load_ushort v196, v219, s[36:39], s35 offen
    s_mov_b32 s35, 9216
    buffer_load_ushort v197, v219, s[36:39], s35 offen
    s_mov_b32 s35, 10240
    buffer_load_ushort v198, v219, s[36:39], s35 offen
    s_mov_b32 s35, 11264
    buffer_load_ushort v199, v219, s[36:39], s35 offen
    s_mov_b32 s35, 16384
    buffer_load_ushort v200, v219, s[36:39], s35 offen
    s_mov_b32 s35, 17408
    buffer_load_ushort v201, v219, s[36:39], s35 offen
    s_mov_b32 s35, 18432
    buffer_load_ushort v202, v219, s[36:39], s35 offen
    s_mov_b32 s35, 19456
    buffer_load_ushort v203, v219, s[36:39], s35 offen
    s_mov_b32 s35, 24576
    buffer_load_ushort v204, v219, s[36:39], s35 offen
    s_mov_b32 s35, 25600
    buffer_load_ushort v205, v219, s[36:39], s35 offen
    s_mov_b32 s35, 26624
    buffer_load_ushort v206, v219, s[36:39], s35 offen
    s_mov_b32 s35, 27648
    buffer_load_ushort v207, v219, s[36:39], s35 offen
    v_mov_b32 v160, 0
    v_mov_b32 v161, 0
    v_mov_b32 v162, 0
    v_mov_b32 v163, 0
    v_mov_b32 v164, 0
    v_mov_b32 v165, 0
    v_mov_b32 v166, 0
    v_mov_b32 v167, 0
    v_mov_b32 v168, 0
    v_mov_b32 v169, 0
    v_mov_b32 v170, 0
    v_mov_b32 v171, 0
    v_mov_b32 v172, 0
    v_mov_b32 v173, 0
    v_mov_b32 v174, 0
    v_mov_b32 v175, 0
    s_mov_b32 s31, 0
    s_mov_b32 s32, 0
    buffer_load_dwordx4 v[16:19], v2, s[12:15], s31 offen
    buffer_load_dwordx4 v[20:23], v3, s[12:15], s31 offen
    buffer_load_dwordx4 v[24:27], v4, s[16:19], s32 offen
    buffer_load_dwordx4 v[28:31], v5, s[16:19], s32 offen
    s_mov_b32 s31, 128
    s_mov_b32 s32, 65536
    buffer_load_dwordx4 v[32:35], v2, s[12:15], s31 offen
    buffer_load_dwordx4 v[36:39], v3, s[12:15], s31 offen
    buffer_load_dwordx4 v[40:43], v4, s[16:19], s32 offen
    buffer_load_dwordx4 v[44:47], v5, s[16:19], s32 offen
    s_mov_b32 s31, 256
    s_mov_b32 s32, 131072
    buffer_load_dwordx4 v[48:51], v2, s[12:15], s31 offen
    buffer_load_dwordx4 v[52:55], v3, s[12:15], s31 offen
    buffer_load_dwordx4 v[56:59], v4, s[16:19], s32 offen
    buffer_load_dwordx4 v[60:63], v5, s[16:19], s32 offen
    s_mov_b32 s31, 384
    s_mov_b32 s32, 196608
    buffer_load_dwordx4 v[64:67], v2, s[12:15], s31 offen
    buffer_load_dwordx4 v[68:71], v3, s[12:15], s31 offen
    buffer_load_dwordx4 v[72:75], v4, s[16:19], s32 offen
    buffer_load_dwordx4 v[76:79], v5, s[16:19], s32 offen
    s_mov_b32 s31, 512
    s_mov_b32 s32, 262144
    buffer_load_dwordx4 v[80:83], v2, s[12:15], s31 offen
    buffer_load_dwordx4 v[84:87], v3, s[12:15], s31 offen
    buffer_load_dwordx4 v[88:91], v4, s[16:19], s32 offen
    buffer_load_dwordx4 v[92:95], v5, s[16:19], s32 offen
    s_mov_b32 s31, 640
    s_mov_b32 s32, 327680
    buffer_load_dwordx4 v[96:99], v2, s[12:15], s31 offen
    buffer_load_dwordx4 v[100:103], v3, s[12:15], s31 offen
    buffer_load_dwordx4 v[104:107], v4, s[16:19], s32 offen
    buffer_load_dwordx4 v[108:111], v5, s[16:19], s32 offen
    s_mov_b32 s31, 768
    s_mov_b32 s32, 393216
    buffer_load_dwordx4 v[112:115], v2, s[12:15], s31 offen
    buffer_load_dwordx4 v[116:119], v3, s[12:15], s31 offen
    buffer_load_dwordx4 v[120:123], v4, s[16:19], s32 offen
    buffer_load_dwordx4 v[124:127], v5, s[16:19], s32 offen
    s_mov_b32 s31, 896
    s_mov_b32 s32, 458752
    buffer_load_dwordx4 v[128:131], v2, s[12:15], s31 offen
    buffer_load_dwordx4 v[132:135], v3, s[12:15], s31 offen
    buffer_load_dwordx4 v[136:139], v4, s[16:19], s32 offen
    buffer_load_dwordx4 v[140:143], v5, s[16:19], s32 offen
    s_waitcnt vmcnt(28)
    ds_write_b128 v6, v[16:19] offset:0
    ds_write_b128 v6, v[20:23] offset:4608
    ds_write_b128 v7, v[24:27] offset:0
    ds_write_b128 v7, v[28:31] offset:6144
    s_waitcnt lgkmcnt(0)
    s_barrier
    ds_read_b128 v[144:147], v8 offset:0
    ds_read_b64_tr_b16 v[152:153], v9 offset:0
    ds_read_b64_tr_b16 v[154:155], v9 offset:768
    ds_read_b128 v[148:151], v8 offset:32
    ds_read_b64_tr_b16 v[156:157], v9 offset:3072
    ds_read_b64_tr_b16 v[158:159], v9 offset:3840
    s_waitcnt lgkmcnt(3)
    v_mfma_f32_32x32x16_bf16 v[160:175], v[144:147], v[152:155], v[160:175]
    ds_read_b128 v[144:147], v8 offset:64
    ds_read_b64_tr_b16 v[152:153], v9 offset:6144
    ds_read_b64_tr_b16 v[154:155], v9 offset:6912
    s_waitcnt lgkmcnt(3)
    v_mfma_f32_32x32x16_bf16 v[160:175], v[148:151], v[156:159], v[160:175]
    ds_read_b128 v[148:151], v8 offset:96
    ds_read_b64_tr_b16 v[156:157], v9 offset:9216
    ds_read_b64_tr_b16 v[158:159], v9 offset:9984
    s_waitcnt lgkmcnt(3)
    v_mfma_f32_32x32x16_bf16 v[160:175], v[144:147], v[152:155], v[160:175]
    s_waitcnt lgkmcnt(0)
    v_mfma_f32_32x32x16_bf16 v[160:175], v[148:151], v[156:159], v[160:175]
    s_waitcnt vmcnt(24)
    ds_write_b128 v6, v[32:35] offset:21504
    ds_write_b128 v6, v[36:39] offset:26112
    ds_write_b128 v7, v[40:43] offset:21504
    ds_write_b128 v7, v[44:47] offset:27648
    s_waitcnt lgkmcnt(0)
    s_barrier
    ds_read_b128 v[144:147], v8 offset:21504
    ds_read_b64_tr_b16 v[152:153], v9 offset:21504
    ds_read_b64_tr_b16 v[154:155], v9 offset:22272
    ds_read_b128 v[148:151], v8 offset:21536
    ds_read_b64_tr_b16 v[156:157], v9 offset:24576
    ds_read_b64_tr_b16 v[158:159], v9 offset:25344
    s_waitcnt lgkmcnt(3)
    v_mfma_f32_32x32x16_bf16 v[160:175], v[144:147], v[152:155], v[160:175]
    ds_read_b128 v[144:147], v8 offset:21568
    ds_read_b64_tr_b16 v[152:153], v9 offset:27648
    ds_read_b64_tr_b16 v[154:155], v9 offset:28416
    s_waitcnt lgkmcnt(3)
    v_mfma_f32_32x32x16_bf16 v[160:175], v[148:151], v[156:159], v[160:175]
    ds_read_b128 v[148:151], v8 offset:21600
    ds_read_b64_tr_b16 v[156:157], v9 offset:30720
    ds_read_b64_tr_b16 v[158:159], v9 offset:31488
    s_waitcnt lgkmcnt(3)
    v_mfma_f32_32x32x16_bf16 v[160:175], v[144:147], v[152:155], v[160:175]
    s_waitcnt lgkmcnt(0)
    v_mfma_f32_32x32x16_bf16 v[160:175], v[148:151], v[156:159], v[160:175]
    s_waitcnt vmcnt(20)
    ds_write_b128 v6, v[48:51] offset:0
    ds_write_b128 v6, v[52:55] offset:4608
    ds_write_b128 v7, v[56:59] offset:0
    ds_write_b128 v7, v[60:63] offset:6144
    s_waitcnt lgkmcnt(0)
    s_barrier
    ds_read_b128 v[144:147], v8 offset:0
    ds_read_b64_tr_b16 v[152:153], v9 offset:0
    ds_read_b64_tr_b16 v[154:155], v9 offset:768
    ds_read_b128 v[148:151], v8 offset:32
    ds_read_b64_tr_b16 v[156:157], v9 offset:3072
    ds_read_b64_tr_b16 v[158:159], v9 offset:3840
    s_waitcnt lgkmcnt(3)
    v_mfma_f32_32x32x16_bf16 v[160:175], v[144:147], v[152:155], v[160:175]
    ds_read_b128 v[144:147], v8 offset:64
    ds_read_b64_tr_b16 v[152:153], v9 offset:6144
    ds_read_b64_tr_b16 v[154:155], v9 offset:6912
    s_waitcnt lgkmcnt(3)
    v_mfma_f32_32x32x16_bf16 v[160:175], v[148:151], v[156:159], v[160:175]
    ds_read_b128 v[148:151], v8 offset:96
    ds_read_b64_tr_b16 v[156:157], v9 offset:9216
    ds_read_b64_tr_b16 v[158:159], v9 offset:9984
    s_waitcnt lgkmcnt(3)
    v_mfma_f32_32x32x16_bf16 v[160:175], v[144:147], v[152:155], v[160:175]
    s_waitcnt lgkmcnt(0)
    v_mfma_f32_32x32x16_bf16 v[160:175], v[148:151], v[156:159], v[160:175]
    s_waitcnt vmcnt(16)
    ds_write_b128 v6, v[64:67] offset:21504
    ds_write_b128 v6, v[68:71] offset:26112
    ds_write_b128 v7, v[72:75] offset:21504
    ds_write_b128 v7, v[76:79] offset:27648
    s_waitcnt lgkmcnt(0)
    s_barrier
    ds_read_b128 v[144:147], v8 offset:21504
    ds_read_b64_tr_b16 v[152:153], v9 offset:21504
    ds_read_b64_tr_b16 v[154:155], v9 offset:22272
    ds_read_b128 v[148:151], v8 offset:21536
    ds_read_b64_tr_b16 v[156:157], v9 offset:24576
    ds_read_b64_tr_b16 v[158:159], v9 offset:25344
    s_waitcnt lgkmcnt(3)
    v_mfma_f32_32x32x16_bf16 v[160:175], v[144:147], v[152:155], v[160:175]
    ds_read_b128 v[144:147], v8 offset:21568
    ds_read_b64_tr_b16 v[152:153], v9 offset:27648
    ds_read_b64_tr_b16 v[154:155], v9 offset:28416
    s_waitcnt lgkmcnt(3)
    v_mfma_f32_32x32x16_bf16 v[160:175], v[148:151], v[156:159], v[160:175]
    ds_read_b128 v[148:151], v8 offset:21600
    ds_read_b64_tr_b16 v[156:157], v9 offset:30720
    ds_read_b64_tr_b16 v[158:159], v9 offset:31488
    s_waitcnt lgkmcnt(3)
    v_mfma_f32_32x32x16_bf16 v[160:175], v[144:147], v[152:155], v[160:175]
    s_waitcnt lgkmcnt(0)
    v_mfma_f32_32x32x16_bf16 v[160:175], v[148:151], v[156:159], v[160:175]
    s_waitcnt vmcnt(12)
    ds_write_b128 v6, v[80:83] offset:0
    ds_write_b128 v6, v[84:87] offset:4608
    ds_write_b128 v7, v[88:91] offset:0
    ds_write_b128 v7, v[92:95] offset:6144
    s_waitcnt lgkmcnt(0)
    s_barrier
    ds_read_b128 v[144:147], v8 offset:0
    ds_read_b64_tr_b16 v[152:153], v9 offset:0
    ds_read_b64_tr_b16 v[154:155], v9 offset:768
    ds_read_b128 v[148:151], v8 offset:32
    ds_read_b64_tr_b16 v[156:157], v9 offset:3072
    ds_read_b64_tr_b16 v[158:159], v9 offset:3840
    s_waitcnt lgkmcnt(3)
    v_mfma_f32_32x32x16_bf16 v[160:175], v[144:147], v[152:155], v[160:175]
    ds_read_b128 v[144:147], v8 offset:64
    ds_read_b64_tr_b16 v[152:153], v9 offset:6144
    ds_read_b64_tr_b16 v[154:155], v9 offset:6912
    s_waitcnt lgkmcnt(3)
    v_mfma_f32_32x32x16_bf16 v[160:175], v[148:151], v[156:159], v[160:175]
    ds_read_b128 v[148:151], v8 offset:96
    ds_read_b64_tr_b16 v[156:157], v9 offset:9216
    ds_read_b64_tr_b16 v[158:159], v9 offset:9984
    s_waitcnt lgkmcnt(3)
    v_mfma_f32_32x32x16_bf16 v[160:175], v[144:147], v[152:155], v[160:175]
    s_waitcnt lgkmcnt(0)
    v_mfma_f32_32x32x16_bf16 v[160:175], v[148:151], v[156:159], v[160:175]
    s_waitcnt vmcnt(8)
    ds_write_b128 v6, v[96:99] offset:21504
    ds_write_b128 v6, v[100:103] offset:26112
    ds_write_b128 v7, v[104:107] offset:21504
    ds_write_b128 v7, v[108:111] offset:27648
    s_waitcnt lgkmcnt(0)
    s_barrier
    ds_read_b128 v[144:147], v8 offset:21504
    ds_read_b64_tr_b16 v[152:153], v9 offset:21504
    ds_read_b64_tr_b16 v[154:155], v9 offset:22272
    ds_read_b128 v[148:151], v8 offset:21536
    ds_read_b64_tr_b16 v[156:157], v9 offset:24576
    ds_read_b64_tr_b16 v[158:159], v9 offset:25344
    s_waitcnt lgkmcnt(3)
    v_mfma_f32_32x32x16_bf16 v[160:175], v[144:147], v[152:155], v[160:175]
    ds_read_b128 v[144:147], v8 offset:21568
    ds_read_b64_tr_b16 v[152:153], v9 offset:27648
    ds_read_b64_tr_b16 v[154:155], v9 offset:28416
    s_waitcnt lgkmcnt(3)
    v_mfma_f32_32x32x16_bf16 v[160:175], v[148:151], v[156:159], v[160:175]
    ds_read_b128 v[148:151], v8 offset:21600
    ds_read_b64_tr_b16 v[156:157], v9 offset:30720
    ds_read_b64_tr_b16 v[158:159], v9 offset:31488
    s_waitcnt lgkmcnt(3)
    v_mfma_f32_32x32x16_bf16 v[160:175], v[144:147], v[152:155], v[160:175]
    s_waitcnt lgkmcnt(0)
    v_mfma_f32_32x32x16_bf16 v[160:175], v[148:151], v[156:159], v[160:175]
    s_waitcnt vmcnt(4)
    ds_write_b128 v6, v[112:115] offset:0
    ds_write_b128 v6, v[116:119] offset:4608
    ds_write_b128 v7, v[120:123] offset:0
    ds_write_b128 v7, v[124:127] offset:6144
    s_waitcnt lgkmcnt(0)
    s_barrier
    ds_read_b128 v[144:147], v8 offset:0
    ds_read_b64_tr_b16 v[152:153], v9 offset:0
    ds_read_b64_tr_b16 v[154:155], v9 offset:768
    ds_read_b128 v[148:151], v8 offset:32
    ds_read_b64_tr_b16 v[156:157], v9 offset:3072
    ds_read_b64_tr_b16 v[158:159], v9 offset:3840
    s_waitcnt lgkmcnt(3)
    v_mfma_f32_32x32x16_bf16 v[160:175], v[144:147], v[152:155], v[160:175]
    ds_read_b128 v[144:147], v8 offset:64
    ds_read_b64_tr_b16 v[152:153], v9 offset:6144
    ds_read_b64_tr_b16 v[154:155], v9 offset:6912
    s_waitcnt lgkmcnt(3)
    v_mfma_f32_32x32x16_bf16 v[160:175], v[148:151], v[156:159], v[160:175]
    ds_read_b128 v[148:151], v8 offset:96
    ds_read_b64_tr_b16 v[156:157], v9 offset:9216
    ds_read_b64_tr_b16 v[158:159], v9 offset:9984
    s_waitcnt lgkmcnt(3)
    v_mfma_f32_32x32x16_bf16 v[160:175], v[144:147], v[152:155], v[160:175]
    s_waitcnt lgkmcnt(0)
    v_mfma_f32_32x32x16_bf16 v[160:175], v[148:151], v[156:159], v[160:175]
    s_waitcnt vmcnt(0)
    ds_write_b128 v6, v[128:131] offset:21504
    ds_write_b128 v6, v[132:135] offset:26112
    ds_write_b128 v7, v[136:139] offset:21504
    ds_write_b128 v7, v[140:143] offset:27648
    s_waitcnt lgkmcnt(0)
    s_barrier
    ds_read_b128 v[144:147], v8 offset:21504
    ds_read_b64_tr_b16 v[152:153], v9 offset:21504
    ds_read_b64_tr_b16 v[154:155], v9 offset:22272
    ds_read_b128 v[148:151], v8 offset:21536
    ds_read_b64_tr_b16 v[156:157], v9 offset:24576
    ds_read_b64_tr_b16 v[158:159], v9 offset:25344
    s_waitcnt lgkmcnt(3)
    v_mfma_f32_32x32x16_bf16 v[160:175], v[144:147], v[152:155], v[160:175]
    ds_read_b128 v[144:147], v8 offset:21568
    ds_read_b64_tr_b16 v[152:153], v9 offset:27648
    ds_read_b64_tr_b16 v[154:155], v9 offset:28416
    s_waitcnt lgkmcnt(3)
    v_mfma_f32_32x32x16_bf16 v[160:175], v[148:151], v[156:159], v[160:175]
    ds_read_b128 v[148:151], v8 offset:21600
    ds_read_b64_tr_b16 v[156:157], v9 offset:30720
    ds_read_b64_tr_b16 v[158:159], v9 offset:31488
    s_waitcnt lgkmcnt(3)
    v_mfma_f32_32x32x16_bf16 v[160:175], v[144:147], v[152:155], v[160:175]
    s_waitcnt lgkmcnt(0)
    v_mfma_f32_32x32x16_bf16 v[160:175], v[148:151], v[156:159], v[160:175]
    s_nop 15
    s_nop 3
    s_waitcnt vmcnt(0)
    v_lshlrev_b32 v10, 16, v208
    v_lshlrev_b32 v192, 16, v192
    v_mul_f32 v10, v192, v10
    v_cvt_pk_bf16_f32 v10, v10, v10
    v_lshlrev_b32 v10, 16, v10
    v_mul_f32 v10, v176, v10
    v_cvt_pk_bf16_f32 v10, v10, v10
    v_lshlrev_b32 v10, 16, v10
    v_cvt_pk_bf16_f32 v160, v160, v160
    v_lshlrev_b32 v160, 16, v160
    v_sub_f32 v176, 1.0, v176
    v_cvt_pk_bf16_f32 v176, v176, v176
    v_lshlrev_b32 v176, 16, v176
    v_mul_f32 v160, v176, v160
    v_cvt_pk_bf16_f32 v160, v160, v160
    v_lshlrev_b32 v160, 16, v160
    v_add_f32 v160, v10, v160
    v_cvt_pk_bf16_f32 v160, v160, v160
    s_mov_b32 s35, 0
    buffer_store_short v160, v219, s[40:43], s35 offen

    v_and_b32 v10, 0xffff0000, v208
    v_lshlrev_b32 v193, 16, v193
    v_mul_f32 v10, v193, v10
    v_cvt_pk_bf16_f32 v10, v10, v10
    v_lshlrev_b32 v10, 16, v10
    v_mul_f32 v10, v177, v10
    v_cvt_pk_bf16_f32 v10, v10, v10
    v_lshlrev_b32 v10, 16, v10
    v_cvt_pk_bf16_f32 v161, v161, v161
    v_lshlrev_b32 v161, 16, v161
    v_sub_f32 v177, 1.0, v177
    v_cvt_pk_bf16_f32 v177, v177, v177
    v_lshlrev_b32 v177, 16, v177
    v_mul_f32 v161, v177, v161
    v_cvt_pk_bf16_f32 v161, v161, v161
    v_lshlrev_b32 v161, 16, v161
    v_add_f32 v161, v10, v161
    v_cvt_pk_bf16_f32 v161, v161, v161
    s_mov_b32 s35, 1024
    buffer_store_short v161, v219, s[40:43], s35 offen

    v_lshlrev_b32 v10, 16, v209
    v_lshlrev_b32 v194, 16, v194
    v_mul_f32 v10, v194, v10
    v_cvt_pk_bf16_f32 v10, v10, v10
    v_lshlrev_b32 v10, 16, v10
    v_mul_f32 v10, v178, v10
    v_cvt_pk_bf16_f32 v10, v10, v10
    v_lshlrev_b32 v10, 16, v10
    v_cvt_pk_bf16_f32 v162, v162, v162
    v_lshlrev_b32 v162, 16, v162
    v_sub_f32 v178, 1.0, v178
    v_cvt_pk_bf16_f32 v178, v178, v178
    v_lshlrev_b32 v178, 16, v178
    v_mul_f32 v162, v178, v162
    v_cvt_pk_bf16_f32 v162, v162, v162
    v_lshlrev_b32 v162, 16, v162
    v_add_f32 v162, v10, v162
    v_cvt_pk_bf16_f32 v162, v162, v162
    s_mov_b32 s35, 2048
    buffer_store_short v162, v219, s[40:43], s35 offen

    v_and_b32 v10, 0xffff0000, v209
    v_lshlrev_b32 v195, 16, v195
    v_mul_f32 v10, v195, v10
    v_cvt_pk_bf16_f32 v10, v10, v10
    v_lshlrev_b32 v10, 16, v10
    v_mul_f32 v10, v179, v10
    v_cvt_pk_bf16_f32 v10, v10, v10
    v_lshlrev_b32 v10, 16, v10
    v_cvt_pk_bf16_f32 v163, v163, v163
    v_lshlrev_b32 v163, 16, v163
    v_sub_f32 v179, 1.0, v179
    v_cvt_pk_bf16_f32 v179, v179, v179
    v_lshlrev_b32 v179, 16, v179
    v_mul_f32 v163, v179, v163
    v_cvt_pk_bf16_f32 v163, v163, v163
    v_lshlrev_b32 v163, 16, v163
    v_add_f32 v163, v10, v163
    v_cvt_pk_bf16_f32 v163, v163, v163
    s_mov_b32 s35, 3072
    buffer_store_short v163, v219, s[40:43], s35 offen

    v_lshlrev_b32 v10, 16, v210
    v_lshlrev_b32 v196, 16, v196
    v_mul_f32 v10, v196, v10
    v_cvt_pk_bf16_f32 v10, v10, v10
    v_lshlrev_b32 v10, 16, v10
    v_mul_f32 v10, v180, v10
    v_cvt_pk_bf16_f32 v10, v10, v10
    v_lshlrev_b32 v10, 16, v10
    v_cvt_pk_bf16_f32 v164, v164, v164
    v_lshlrev_b32 v164, 16, v164
    v_sub_f32 v180, 1.0, v180
    v_cvt_pk_bf16_f32 v180, v180, v180
    v_lshlrev_b32 v180, 16, v180
    v_mul_f32 v164, v180, v164
    v_cvt_pk_bf16_f32 v164, v164, v164
    v_lshlrev_b32 v164, 16, v164
    v_add_f32 v164, v10, v164
    v_cvt_pk_bf16_f32 v164, v164, v164
    s_mov_b32 s35, 8192
    buffer_store_short v164, v219, s[40:43], s35 offen

    v_and_b32 v10, 0xffff0000, v210
    v_lshlrev_b32 v197, 16, v197
    v_mul_f32 v10, v197, v10
    v_cvt_pk_bf16_f32 v10, v10, v10
    v_lshlrev_b32 v10, 16, v10
    v_mul_f32 v10, v181, v10
    v_cvt_pk_bf16_f32 v10, v10, v10
    v_lshlrev_b32 v10, 16, v10
    v_cvt_pk_bf16_f32 v165, v165, v165
    v_lshlrev_b32 v165, 16, v165
    v_sub_f32 v181, 1.0, v181
    v_cvt_pk_bf16_f32 v181, v181, v181
    v_lshlrev_b32 v181, 16, v181
    v_mul_f32 v165, v181, v165
    v_cvt_pk_bf16_f32 v165, v165, v165
    v_lshlrev_b32 v165, 16, v165
    v_add_f32 v165, v10, v165
    v_cvt_pk_bf16_f32 v165, v165, v165
    s_mov_b32 s35, 9216
    buffer_store_short v165, v219, s[40:43], s35 offen

    v_lshlrev_b32 v10, 16, v211
    v_lshlrev_b32 v198, 16, v198
    v_mul_f32 v10, v198, v10
    v_cvt_pk_bf16_f32 v10, v10, v10
    v_lshlrev_b32 v10, 16, v10
    v_mul_f32 v10, v182, v10
    v_cvt_pk_bf16_f32 v10, v10, v10
    v_lshlrev_b32 v10, 16, v10
    v_cvt_pk_bf16_f32 v166, v166, v166
    v_lshlrev_b32 v166, 16, v166
    v_sub_f32 v182, 1.0, v182
    v_cvt_pk_bf16_f32 v182, v182, v182
    v_lshlrev_b32 v182, 16, v182
    v_mul_f32 v166, v182, v166
    v_cvt_pk_bf16_f32 v166, v166, v166
    v_lshlrev_b32 v166, 16, v166
    v_add_f32 v166, v10, v166
    v_cvt_pk_bf16_f32 v166, v166, v166
    s_mov_b32 s35, 10240
    buffer_store_short v166, v219, s[40:43], s35 offen

    v_and_b32 v10, 0xffff0000, v211
    v_lshlrev_b32 v199, 16, v199
    v_mul_f32 v10, v199, v10
    v_cvt_pk_bf16_f32 v10, v10, v10
    v_lshlrev_b32 v10, 16, v10
    v_mul_f32 v10, v183, v10
    v_cvt_pk_bf16_f32 v10, v10, v10
    v_lshlrev_b32 v10, 16, v10
    v_cvt_pk_bf16_f32 v167, v167, v167
    v_lshlrev_b32 v167, 16, v167
    v_sub_f32 v183, 1.0, v183
    v_cvt_pk_bf16_f32 v183, v183, v183
    v_lshlrev_b32 v183, 16, v183
    v_mul_f32 v167, v183, v167
    v_cvt_pk_bf16_f32 v167, v167, v167
    v_lshlrev_b32 v167, 16, v167
    v_add_f32 v167, v10, v167
    v_cvt_pk_bf16_f32 v167, v167, v167
    s_mov_b32 s35, 11264
    buffer_store_short v167, v219, s[40:43], s35 offen

    v_lshlrev_b32 v10, 16, v212
    v_lshlrev_b32 v200, 16, v200
    v_mul_f32 v10, v200, v10
    v_cvt_pk_bf16_f32 v10, v10, v10
    v_lshlrev_b32 v10, 16, v10
    v_mul_f32 v10, v184, v10
    v_cvt_pk_bf16_f32 v10, v10, v10
    v_lshlrev_b32 v10, 16, v10
    v_cvt_pk_bf16_f32 v168, v168, v168
    v_lshlrev_b32 v168, 16, v168
    v_sub_f32 v184, 1.0, v184
    v_cvt_pk_bf16_f32 v184, v184, v184
    v_lshlrev_b32 v184, 16, v184
    v_mul_f32 v168, v184, v168
    v_cvt_pk_bf16_f32 v168, v168, v168
    v_lshlrev_b32 v168, 16, v168
    v_add_f32 v168, v10, v168
    v_cvt_pk_bf16_f32 v168, v168, v168
    s_mov_b32 s35, 16384
    buffer_store_short v168, v219, s[40:43], s35 offen

    v_and_b32 v10, 0xffff0000, v212
    v_lshlrev_b32 v201, 16, v201
    v_mul_f32 v10, v201, v10
    v_cvt_pk_bf16_f32 v10, v10, v10
    v_lshlrev_b32 v10, 16, v10
    v_mul_f32 v10, v185, v10
    v_cvt_pk_bf16_f32 v10, v10, v10
    v_lshlrev_b32 v10, 16, v10
    v_cvt_pk_bf16_f32 v169, v169, v169
    v_lshlrev_b32 v169, 16, v169
    v_sub_f32 v185, 1.0, v185
    v_cvt_pk_bf16_f32 v185, v185, v185
    v_lshlrev_b32 v185, 16, v185
    v_mul_f32 v169, v185, v169
    v_cvt_pk_bf16_f32 v169, v169, v169
    v_lshlrev_b32 v169, 16, v169
    v_add_f32 v169, v10, v169
    v_cvt_pk_bf16_f32 v169, v169, v169
    s_mov_b32 s35, 17408
    buffer_store_short v169, v219, s[40:43], s35 offen

    v_lshlrev_b32 v10, 16, v213
    v_lshlrev_b32 v202, 16, v202
    v_mul_f32 v10, v202, v10
    v_cvt_pk_bf16_f32 v10, v10, v10
    v_lshlrev_b32 v10, 16, v10
    v_mul_f32 v10, v186, v10
    v_cvt_pk_bf16_f32 v10, v10, v10
    v_lshlrev_b32 v10, 16, v10
    v_cvt_pk_bf16_f32 v170, v170, v170
    v_lshlrev_b32 v170, 16, v170
    v_sub_f32 v186, 1.0, v186
    v_cvt_pk_bf16_f32 v186, v186, v186
    v_lshlrev_b32 v186, 16, v186
    v_mul_f32 v170, v186, v170
    v_cvt_pk_bf16_f32 v170, v170, v170
    v_lshlrev_b32 v170, 16, v170
    v_add_f32 v170, v10, v170
    v_cvt_pk_bf16_f32 v170, v170, v170
    s_mov_b32 s35, 18432
    buffer_store_short v170, v219, s[40:43], s35 offen

    v_and_b32 v10, 0xffff0000, v213
    v_lshlrev_b32 v203, 16, v203
    v_mul_f32 v10, v203, v10
    v_cvt_pk_bf16_f32 v10, v10, v10
    v_lshlrev_b32 v10, 16, v10
    v_mul_f32 v10, v187, v10
    v_cvt_pk_bf16_f32 v10, v10, v10
    v_lshlrev_b32 v10, 16, v10
    v_cvt_pk_bf16_f32 v171, v171, v171
    v_lshlrev_b32 v171, 16, v171
    v_sub_f32 v187, 1.0, v187
    v_cvt_pk_bf16_f32 v187, v187, v187
    v_lshlrev_b32 v187, 16, v187
    v_mul_f32 v171, v187, v171
    v_cvt_pk_bf16_f32 v171, v171, v171
    v_lshlrev_b32 v171, 16, v171
    v_add_f32 v171, v10, v171
    v_cvt_pk_bf16_f32 v171, v171, v171
    s_mov_b32 s35, 19456
    buffer_store_short v171, v219, s[40:43], s35 offen

    v_lshlrev_b32 v10, 16, v214
    v_lshlrev_b32 v204, 16, v204
    v_mul_f32 v10, v204, v10
    v_cvt_pk_bf16_f32 v10, v10, v10
    v_lshlrev_b32 v10, 16, v10
    v_mul_f32 v10, v188, v10
    v_cvt_pk_bf16_f32 v10, v10, v10
    v_lshlrev_b32 v10, 16, v10
    v_cvt_pk_bf16_f32 v172, v172, v172
    v_lshlrev_b32 v172, 16, v172
    v_sub_f32 v188, 1.0, v188
    v_cvt_pk_bf16_f32 v188, v188, v188
    v_lshlrev_b32 v188, 16, v188
    v_mul_f32 v172, v188, v172
    v_cvt_pk_bf16_f32 v172, v172, v172
    v_lshlrev_b32 v172, 16, v172
    v_add_f32 v172, v10, v172
    v_cvt_pk_bf16_f32 v172, v172, v172
    s_mov_b32 s35, 24576
    buffer_store_short v172, v219, s[40:43], s35 offen

    v_and_b32 v10, 0xffff0000, v214
    v_lshlrev_b32 v205, 16, v205
    v_mul_f32 v10, v205, v10
    v_cvt_pk_bf16_f32 v10, v10, v10
    v_lshlrev_b32 v10, 16, v10
    v_mul_f32 v10, v189, v10
    v_cvt_pk_bf16_f32 v10, v10, v10
    v_lshlrev_b32 v10, 16, v10
    v_cvt_pk_bf16_f32 v173, v173, v173
    v_lshlrev_b32 v173, 16, v173
    v_sub_f32 v189, 1.0, v189
    v_cvt_pk_bf16_f32 v189, v189, v189
    v_lshlrev_b32 v189, 16, v189
    v_mul_f32 v173, v189, v173
    v_cvt_pk_bf16_f32 v173, v173, v173
    v_lshlrev_b32 v173, 16, v173
    v_add_f32 v173, v10, v173
    v_cvt_pk_bf16_f32 v173, v173, v173
    s_mov_b32 s35, 25600
    buffer_store_short v173, v219, s[40:43], s35 offen

    v_lshlrev_b32 v10, 16, v215
    v_lshlrev_b32 v206, 16, v206
    v_mul_f32 v10, v206, v10
    v_cvt_pk_bf16_f32 v10, v10, v10
    v_lshlrev_b32 v10, 16, v10
    v_mul_f32 v10, v190, v10
    v_cvt_pk_bf16_f32 v10, v10, v10
    v_lshlrev_b32 v10, 16, v10
    v_cvt_pk_bf16_f32 v174, v174, v174
    v_lshlrev_b32 v174, 16, v174
    v_sub_f32 v190, 1.0, v190
    v_cvt_pk_bf16_f32 v190, v190, v190
    v_lshlrev_b32 v190, 16, v190
    v_mul_f32 v174, v190, v174
    v_cvt_pk_bf16_f32 v174, v174, v174
    v_lshlrev_b32 v174, 16, v174
    v_add_f32 v174, v10, v174
    v_cvt_pk_bf16_f32 v174, v174, v174
    s_mov_b32 s35, 26624
    buffer_store_short v174, v219, s[40:43], s35 offen

    v_and_b32 v10, 0xffff0000, v215
    v_lshlrev_b32 v207, 16, v207
    v_mul_f32 v10, v207, v10
    v_cvt_pk_bf16_f32 v10, v10, v10
    v_lshlrev_b32 v10, 16, v10
    v_mul_f32 v10, v191, v10
    v_cvt_pk_bf16_f32 v10, v10, v10
    v_lshlrev_b32 v10, 16, v10
    v_cvt_pk_bf16_f32 v175, v175, v175
    v_lshlrev_b32 v175, 16, v175
    v_sub_f32 v191, 1.0, v191
    v_cvt_pk_bf16_f32 v191, v191, v191
    v_lshlrev_b32 v191, 16, v191
    v_mul_f32 v175, v191, v175
    v_cvt_pk_bf16_f32 v175, v175, v175
    v_lshlrev_b32 v175, 16, v175
    v_add_f32 v175, v10, v175
    v_cvt_pk_bf16_f32 v175, v175, v175
    s_mov_b32 s35, 27648
    buffer_store_short v175, v219, s[40:43], s35 offen

    s_endpgm
Lexit_gated_mix__ssm_conv_h3__sliding_block__prompt_kernel:
    s_endpgm
.section .rodata,"a"
.p2align 6
.amdhsa_kernel k1_kernel
  .amdhsa_next_free_vgpr 256
  .amdhsa_next_free_sgpr 100
  .amdhsa_accum_offset 256
  .amdhsa_group_segment_fixed_size 0
  .amdhsa_kernarg_size 104
  .amdhsa_user_sgpr_count 2
  .amdhsa_user_sgpr_kernarg_segment_ptr 1
  .amdhsa_system_sgpr_workgroup_id_x 1
.end_amdhsa_kernel
.p2align 6
.amdhsa_kernel k2_kernel
  .amdhsa_next_free_vgpr 128
  .amdhsa_next_free_sgpr 100
  .amdhsa_accum_offset 128
  .amdhsa_group_segment_fixed_size 0
  .amdhsa_kernarg_size 104
  .amdhsa_user_sgpr_count 2
  .amdhsa_user_sgpr_kernarg_segment_ptr 1
  .amdhsa_system_sgpr_workgroup_id_x 1
.end_amdhsa_kernel
.p2align 6
.amdhsa_kernel gated_mix__ssm_conv_h3__sliding_block__prompt_kernel
  .amdhsa_next_free_vgpr 220
  .amdhsa_next_free_sgpr 100
  .amdhsa_accum_offset 220
  .amdhsa_group_segment_fixed_size 0
  .amdhsa_kernarg_size 104
  .amdhsa_user_sgpr_count 2
  .amdhsa_user_sgpr_kernarg_segment_ptr 1
  .amdhsa_system_sgpr_workgroup_id_x 1
.end_amdhsa_kernel
```
